```python
import torch

def _softmax(x, axis=-1):
    return torch.softmax(x, dim=axis)
def _gelu(x):
    return torch.nn.functional.gelu(x, approximate="tanh")
def _silu(x):
    return torch.nn.functional.silu(x)
def _sigmoid(x):
    return torch.sigmoid(x)
def _layernorm(x, axis=-1, eps=1e-5):
    m = x.mean(dim=axis, keepdim=True)
    v = x.var(dim=axis, keepdim=True, unbiased=False)
    return (x - m) / torch.sqrt(v + eps)
def _scatter_add(tgt, idx, src, axis=0):
    return tgt.clone().index_add_(axis, idx, src)
def _segment_sum(src, seg, n):
    out = torch.zeros((n,) + src.shape[1:], dtype=src.dtype)
    return out.index_add_(0, seg, src)
def _pad(x, pw):
    flat = tuple(v for pair in reversed(pw) for v in pair)
    return torch.nn.functional.pad(x, flat)

kernel_name = 'gated_mix__mha_block__softmax_full_mha__prompt'

def setup_inputs():

    _w = (lambda a: (lambda t: t.to(torch.bfloat16) if t.is_floating_point() else t)(torch.as_tensor(a)))
    def _A_setup():
        B, S, D, H = 1, 2048, 448, 16
        return {
            "x": _w((lambda *s: torch.randn(*s, dtype=torch.bfloat16) * 0.05)(B, S, D)),
            "wqkv": _w((lambda *s: torch.randn(*s, dtype=torch.bfloat16) * 0.8)(D, 3 * D)),
            "wo": _w((lambda *s: torch.randn(*s, dtype=torch.bfloat16) * 0.05)(D, D)),
        }
    _A_in = _A_setup()

    def _B_setup():
        B, S, D = 1, 2048, 448
        return {
            "x": _w((lambda *s: torch.randn(*s, dtype=torch.bfloat16) * 0.05)(B, S, D)),
            "wqkv": _w((lambda *s: torch.randn(*s, dtype=torch.bfloat16) * 0.8)(D, 3 * D)),
            "wo": _w((lambda *s: torch.randn(*s, dtype=torch.bfloat16) * 0.05)(D, D)),
        }
    _B_in = _B_setup()

    return {
        "A_x": _A_in["x"],
        "A_wqkv": _A_in["wqkv"],
        "A_wo": _A_in["wo"],
        "B_x": _B_in["x"],
        "B_wqkv": _B_in["wqkv"],
        "B_wo": _B_in["wo"],
        "gate_w": _w((lambda *s: torch.randn(*s, dtype=torch.bfloat16) * 0.05)(448) * 16.0),
    }

def reference(A_x, A_wqkv, A_wo, B_x, B_wqkv, B_wo, gate_w):
    def _A_ref(x, wqkv, wo):
        B, S, D = x.shape
        H = 16
        Dh = D // H
        qkv = (lambda x, *d: x.permute(*d))((x @ wqkv).reshape(B, S, 3, H, Dh), 2, 0, 3, 1, 4)
        q, k, v = qkv[0], qkv[1], qkv[2]
        scores = torch.einsum("bhqd,bhkd->bhqk", q, k) * (Dh ** -0.5)
        p = _softmax(scores, axis=-1)
        o = torch.einsum("bhqk,bhkd->bhqd", p, v)
        return (lambda x, *d: x.permute(*d))(o, 0, 2, 1, 3).reshape(B, S, D) @ wo

    def _B_ref(x, wqkv, wo):
        B, S, D = x.shape
        H = 16; Dh = D // H
        qkv = (lambda x, *d: x.permute(*d))((x @ wqkv).reshape(B, S, 3, H, Dh), 2, 0, 3, 1, 4)
        q, k, v = qkv[0], qkv[1], qkv[2]
        scale = Dh ** -0.5
        scores = torch.einsum("bhqd,bhkd->bhqk", q, k) * scale
        p = _softmax(scores, axis=-1)
        o = torch.einsum("bhqk,bhkd->bhqd", p, v)
        return (lambda x, *d: x.permute(*d))(o, 0, 2, 1, 3).reshape(B, S, D) @ wo

    x = A_x
    g = _sigmoid((x * gate_w).sum(-1, keepdims=True))
    a = _A_ref(x, A_wqkv, A_wo)
    b = _B_ref(x, B_wqkv, B_wo)
    return g * a + (1 - g) * b
```

```asm
; @launch grid=(256,1,1) block=(512,1,1) lds=163840
.amdgcn_target "amdgcn-amd-amdhsa--gfx950"
.text
.globl gated_mix__mha_block__softmax_full_mha__prompt_kernel
.p2align 8
.type gated_mix__mha_block__softmax_full_mha__prompt_kernel,@function
gated_mix__mha_block__softmax_full_mha__prompt_kernel:
    s_cmp_ge_u32 s2, 256
    s_cbranch_scc1 F_done
    s_load_dwordx16 s[16:31], s[0:1], 0
    s_load_dwordx4 s[32:35], s[0:1], 64
    s_lshr_b32 s4, s2, 3
    s_bfe_u32 s7, s2, 0x10002
    s_bfe_u32 s3, s2, 0x10001
    s_lshl_b32 s3, s3, 3
    s_and_b32 s8, s4, 7
    s_add_u32 s8, s8, s3
    s_and_b32 s3, s2, 1
    s_lshl_b32 s3, s3, 2
    s_lshr_b32 s6, s4, 3
    s_add_u32 s6, s6, s3
    s_lshl_b32 s5, s7, 4
    s_add_u32 s5, s5, s8
    v_and_b32 v1, 63, v0
    v_lshrrev_b32 v5, 6, v0
    v_lshrrev_b32 v6, 3, v1
    v_readfirstlane_b32 s9, v5
    s_nop 0
    v_and_b32 v7, 7, v1
    v_lshrrev_b32 v5, 4, v1
    v_xor_b32 v7, v7, v5
    v_mul_u32_u24 v6, 896, v6
    v_lshl_add_u32 v10, v7, 4, v6
    v_xor_b32 v11, 64, v10
    v_mul_u32_u24 v6, 43, v1
    v_lshrrev_b32 v6, 9, v6
    v_mul_u32_u24 v7, 12, v6
    v_sub_u32 v7, v1, v7
    v_lshrrev_b32 v5, 2, v7
    v_and_b32 v7, 3, v7
    v_mul_u32_u24 v6, 2688, v6
    v_mul_u32_u24 v5, 896, v5
    v_lshlrev_b32 v7, 4, v7
    v_add3_u32 v12, v6, v7, v5
    v_lshlrev_b32 v2, 4, v1
    v_lshlrev_b32 v3, 4, v0
    v_and_b32 v6, 31, v1
    v_lshrrev_b32 v7, 5, v1
    v_bfe_u32 v5, v1, 1, 3
    v_xor_b32 v5, v5, v7
    v_lshlrev_b32 v5, 4, v5
    v_lshl_add_u32 v5, v6, 7, v5
    s_lshl_b32 s57, s9, 12
    v_add_u32 v14, s57, v5
    v_xor_b32 v15, 32, v14
    v_xor_b32 v16, 64, v14
    v_xor_b32 v17, 96, v14
    v_add_u32 v124, 65536, v14
    v_add_u32 v125, 65536, v15
    v_add_u32 v126, 65536, v16
    v_add_u32 v127, 65536, v17
    v_lshlrev_b32 v7, 4, v7
    v_add_u32 v20, 147456, v7
    v_cmp_eq_u32 vcc, 28, v6
    v_mov_b32 v6, 0x3f803f80
    v_mov_b32 v7, 0
    v_cndmask_b32 v21, v7, v6, vcc
    v_lshrrev_b32 v5, 4, v1
    v_and_b32 v6, 1, v5
    v_lshrrev_b32 v5, 1, v5
    v_bfe_u32 v7, v1, 2, 2
    v_lshl_add_u32 v5, v5, 3, v7
    v_mul_u32_u24 v5, 192, v5
    v_lshl_add_u32 v5, v6, 5, v5
    v_and_b32 v6, 3, v1
    v_lshl_add_u32 v18, v6, 3, v5
    v_add_u32 v18, 98304, v18
    s_lshl_b32 s10, s6, 3
    s_add_u32 s10, s10, s9
    s_mul_i32 s56, s10, 28672
    s_mul_i32 s58, s9, 10752
    s_mul_i32 s59, s8, 56
    s_add_u32 s58, s58, s59
    s_mul_i32 s59, s9, 768
    s_mov_b32 s60, 0x10000000
    s_mov_b32 s61, 0x10000000
    s_waitcnt lgkmcnt(0)
    s_cmp_eq_u32 s7, 0
    s_cselect_b32 s38, s18, s24
    s_cselect_b32 s39, s19, s25
    s_mov_b32 s40, s16
    s_mov_b32 s41, s17
    s_mov_b32 s42, 1835008
    s_mov_b32 s43, 0x20000
    s_mov_b32 s44, s38
    s_mov_b32 s45, s39
    s_mov_b32 s46, 1204224
    s_mov_b32 s47, 0x20000
    s_mov_b32 s48, s28
    s_mov_b32 s49, s29
    s_mov_b32 s50, 896
    s_mov_b32 s51, 0x20000
    s_mov_b32 s0, -1
    s_mov_b32 s1, 0xffff
    s_mov_b32 s66, -1
    s_mov_b32 s67, 0xffffff
    s_and_b32 s62, s8, 7
    s_and_b32 s63, s6, 3
    s_lshl_b32 s63, s63, 1
    s_add_u32 s62, s62, s63
    s_cmp_ge_u32 s62, 12
    s_cselect_b32 s63, 12, 0
    s_sub_u32 s62, s62, s63
    s_cmp_ge_u32 s62, 6
    s_cselect_b32 s63, 6, 0
    s_sub_u32 s62, s62, s63
    s_add_u32 s62, s62, 1
    s_lshl_b32 s62, s62, 7
    s_mov_b32 s4, s62
    s_mov_b64 exec, s[66:67]
    s_mov_b32 m0, 147456
    s_nop 0
    buffer_load_dwordx4 v2, s[48:51], 0 offen lds
    s_mov_b64 exec, -1
    s_mov_b32 s64, s56
    s_mov_b32 s63, s58
    s_add_u32 m0, s57, 0
    s_add_u32 s65, s64, 0
    buffer_load_dwordx4 v10, s[40:43], s65 offen lds
    s_add_u32 m0, s57, 1024
    s_add_u32 s65, s64, 7168
    buffer_load_dwordx4 v11, s[40:43], s65 offen lds
    s_add_u32 m0, s57, 2048
    s_add_u32 s65, s64, 14336
    buffer_load_dwordx4 v10, s[40:43], s65 offen lds
    s_add_u32 m0, s57, 3072
    s_add_u32 s65, s64, 21504
    buffer_load_dwordx4 v11, s[40:43], s65 offen lds
    s_mov_b64 exec, s[0:1]
    s_add_u32 m0, s59, 98304
    s_add_u32 s65, s63, 0
    buffer_load_dwordx4 v12, s[44:47], s65 offen lds
    s_mov_b64 exec, -1
    s_mov_b64 exec, s[0:1]
    s_add_u32 m0, s59, 104448
    s_add_u32 s65, s63, 86016
    buffer_load_dwordx4 v12, s[44:47], s65 offen lds
    s_mov_b64 exec, -1
    s_barrier
    s_add_u32 s64, s56, s62
    s_mul_i32 s63, s62, 1344
    s_add_u32 s63, s63, s58
    s_add_u32 s62, s62, 128
    s_cmp_eq_u32 s62, 896
    s_cselect_b32 s62, 128, s62
    s_add_u32 m0, s57, 32768
    s_add_u32 s65, s64, 0
    buffer_load_dwordx4 v10, s[40:43], s65 offen lds
    s_add_u32 m0, s57, 33792
    s_add_u32 s65, s64, 7168
    buffer_load_dwordx4 v11, s[40:43], s65 offen lds
    s_add_u32 m0, s57, 34816
    s_add_u32 s65, s64, 14336
    buffer_load_dwordx4 v10, s[40:43], s65 offen lds
    s_add_u32 m0, s57, 35840
    s_add_u32 s65, s64, 21504
    buffer_load_dwordx4 v11, s[40:43], s65 offen lds
    s_mov_b64 exec, s[0:1]
    s_add_u32 m0, s59, 110592
    s_add_u32 s65, s63, 0
    buffer_load_dwordx4 v12, s[44:47], s65 offen lds
    s_mov_b64 exec, -1
    s_mov_b64 exec, s[0:1]
    s_add_u32 m0, s59, 116736
    s_add_u32 s65, s63, 86016
    buffer_load_dwordx4 v12, s[44:47], s65 offen lds
    s_mov_b64 exec, -1
    s_mov_b32 s12, s32
    s_mov_b32 s13, s33
    s_mov_b32 s14, 256
    s_mov_b32 s15, 0x20000
    s_or_b32 s3, s2, s9
    s_cmp_lg_u32 s3, 0
    s_cbranch_scc1 F_notag
    s_memrealtime s[70:71]
    s_waitcnt lgkmcnt(0)
    s_or_b32 s70, s70, 1
    v_mov_b32 v5, s70
    v_mov_b32 v6, 0
    s_mov_b64 exec, 1
    buffer_store_dword v5, v6, s[12:15], 0 offen sc1
    s_mov_b64 exec, -1
F_notag:
    s_lshl_b32 s3, s5, 18
    s_add_u32 s36, s34, s3
    s_addc_u32 s37, s35, 0
    s_mov_b32 s38, 0x40000
    s_mov_b32 s39, 0x20000
    v_mov_b32 v64, 0
    v_mov_b32 v65, 0
    v_mov_b32 v66, 0
    v_mov_b32 v67, 0
    v_mov_b32 v68, 0
    v_mov_b32 v69, 0
    v_mov_b32 v70, 0
    v_mov_b32 v71, 0
    v_mov_b32 v72, 0
    v_mov_b32 v73, 0
    v_mov_b32 v74, 0
    v_mov_b32 v75, 0
    v_mov_b32 v76, 0
    v_mov_b32 v77, 0
    v_mov_b32 v78, 0
    v_mov_b32 v79, 0
    v_mov_b32 v80, 0
    v_mov_b32 v81, 0
    v_mov_b32 v82, 0
    v_mov_b32 v83, 0
    v_mov_b32 v84, 0
    v_mov_b32 v85, 0
    v_mov_b32 v86, 0
    v_mov_b32 v87, 0
    v_mov_b32 v88, 0
    v_mov_b32 v89, 0
    v_mov_b32 v90, 0
    v_mov_b32 v91, 0
    v_mov_b32 v92, 0
    v_mov_b32 v93, 0
    v_mov_b32 v94, 0
    v_mov_b32 v95, 0
    v_mov_b32 v96, 0
    v_mov_b32 v97, 0
    v_mov_b32 v98, 0
    v_mov_b32 v99, 0
    v_mov_b32 v100, 0
    v_mov_b32 v101, 0
    v_mov_b32 v102, 0
    v_mov_b32 v103, 0
    v_mov_b32 v104, 0
    v_mov_b32 v105, 0
    v_mov_b32 v106, 0
    v_mov_b32 v107, 0
    v_mov_b32 v108, 0
    v_mov_b32 v109, 0
    v_mov_b32 v110, 0
    v_mov_b32 v111, 0
    s_waitcnt vmcnt(6)
    s_barrier
    ds_read_b128 v[24:27], v14 offset:0
    ds_read_b128 v[28:31], v15 offset:0
    ds_read_b128 v[32:35], v16 offset:0
    ds_read_b128 v[36:39], v17 offset:0
    v_mov_b32 v22, v20
    ds_read_b64_tr_b16 v[40:41], v18 offset:0
    ds_read_b64_tr_b16 v[42:43], v18 offset:768
    ds_read_b64_tr_b16 v[44:45], v18 offset:64
    ds_read_b64_tr_b16 v[46:47], v18 offset:832
    ds_read_b64_tr_b16 v[48:49], v18 offset:128
    ds_read_b64_tr_b16 v[50:51], v18 offset:896
    s_mov_b64 exec, s[60:61]
    ds_read_b128 v[40:43], v22 offset:0
    s_mov_b64 exec, -1
    s_waitcnt lgkmcnt(0)
    ds_read_b64_tr_b16 v[52:53], v18 offset:3072
    ds_read_b64_tr_b16 v[54:55], v18 offset:3840
    ds_read_b64_tr_b16 v[56:57], v18 offset:3136
    ds_read_b64_tr_b16 v[58:59], v18 offset:3904
    ds_read_b64_tr_b16 v[60:61], v18 offset:3200
    ds_read_b64_tr_b16 v[62:63], v18 offset:3968
    s_mov_b64 exec, s[60:61]
    ds_read_b128 v[52:55], v22 offset:32
    s_mov_b64 exec, -1
    v_mfma_f32_32x32x16_bf16 v[64:79], v[40:43], v[24:27], v[64:79]
    v_mfma_f32_32x32x16_bf16 v[80:95], v[44:47], v[24:27], v[80:95]
    v_mfma_f32_32x32x16_bf16 v[96:111], v[24:27], v[48:51], v[96:111]
    s_add_u32 s64, s56, s62
    s_mul_i32 s63, s62, 1344
    s_add_u32 s63, s63, s58
    s_add_u32 s62, s62, 128
    s_cmp_eq_u32 s62, 896
    s_cselect_b32 s62, 128, s62
    s_add_u32 m0, s57, 65536
    s_add_u32 s65, s64, 0
    buffer_load_dwordx4 v10, s[40:43], s65 offen lds
    s_add_u32 m0, s57, 66560
    s_add_u32 s65, s64, 7168
    buffer_load_dwordx4 v11, s[40:43], s65 offen lds
    s_waitcnt lgkmcnt(0)
    ds_read_b64_tr_b16 v[40:41], v18 offset:6144
    ds_read_b64_tr_b16 v[42:43], v18 offset:6912
    ds_read_b64_tr_b16 v[44:45], v18 offset:6208
    ds_read_b64_tr_b16 v[46:47], v18 offset:6976
    ds_read_b64_tr_b16 v[48:49], v18 offset:6272
    ds_read_b64_tr_b16 v[50:51], v18 offset:7040
    s_mov_b64 exec, s[60:61]
    ds_read_b128 v[40:43], v22 offset:64
    s_mov_b64 exec, -1
    v_mfma_f32_32x32x16_bf16 v[64:79], v[52:55], v[28:31], v[64:79]
    v_mfma_f32_32x32x16_bf16 v[80:95], v[56:59], v[28:31], v[80:95]
    v_mfma_f32_32x32x16_bf16 v[96:111], v[28:31], v[60:63], v[96:111]
    s_add_u32 m0, s57, 67584
    s_add_u32 s65, s64, 14336
    buffer_load_dwordx4 v10, s[40:43], s65 offen lds
    s_add_u32 m0, s57, 68608
    s_add_u32 s65, s64, 21504
    buffer_load_dwordx4 v11, s[40:43], s65 offen lds
    s_waitcnt lgkmcnt(0)
    s_waitcnt vmcnt(4)
    s_barrier
    ds_read_b128 v[128:131], v14 offset:32768
    ds_read_b128 v[132:135], v15 offset:32768
    ds_read_b128 v[136:139], v16 offset:32768
    ds_read_b128 v[140:143], v17 offset:32768
    ds_read_b64_tr_b16 v[52:53], v18 offset:9216
    ds_read_b64_tr_b16 v[54:55], v18 offset:9984
    ds_read_b64_tr_b16 v[56:57], v18 offset:9280
    ds_read_b64_tr_b16 v[58:59], v18 offset:10048
    ds_read_b64_tr_b16 v[60:61], v18 offset:9344
    ds_read_b64_tr_b16 v[62:63], v18 offset:10112
    s_mov_b64 exec, s[60:61]
    ds_read_b128 v[52:55], v22 offset:96
    s_mov_b64 exec, -1
    v_mfma_f32_32x32x16_bf16 v[64:79], v[40:43], v[32:35], v[64:79]
    v_mfma_f32_32x32x16_bf16 v[80:95], v[44:47], v[32:35], v[80:95]
    v_mfma_f32_32x32x16_bf16 v[96:111], v[32:35], v[48:51], v[96:111]
    s_mov_b64 exec, s[0:1]
    s_add_u32 m0, s59, 122880
    s_add_u32 s65, s63, 0
    buffer_load_dwordx4 v12, s[44:47], s65 offen lds
    s_mov_b64 exec, -1
    s_mov_b64 exec, s[0:1]
    s_add_u32 m0, s59, 129024
    s_add_u32 s65, s63, 86016
    buffer_load_dwordx4 v12, s[44:47], s65 offen lds
    s_mov_b64 exec, -1
    s_waitcnt lgkmcnt(0)
    v_add_u32 v22, s4, v20
    s_add_u32 s4, s4, 128
    s_cmp_eq_u32 s4, 896
    s_cselect_b32 s4, 128, s4
    ds_read_b64_tr_b16 v[40:41], v18 offset:12288
    ds_read_b64_tr_b16 v[42:43], v18 offset:13056
    ds_read_b64_tr_b16 v[44:45], v18 offset:12352
    ds_read_b64_tr_b16 v[46:47], v18 offset:13120
    ds_read_b64_tr_b16 v[48:49], v18 offset:12416
    ds_read_b64_tr_b16 v[50:51], v18 offset:13184
    s_mov_b64 exec, s[60:61]
    ds_read_b128 v[40:43], v22 offset:0
    s_mov_b64 exec, -1
    v_mfma_f32_32x32x16_bf16 v[64:79], v[52:55], v[36:39], v[64:79]
    v_mfma_f32_32x32x16_bf16 v[80:95], v[56:59], v[36:39], v[80:95]
    v_mfma_f32_32x32x16_bf16 v[96:111], v[36:39], v[60:63], v[96:111]
    s_add_u32 s64, s56, s62
    s_mul_i32 s63, s62, 1344
    s_add_u32 s63, s63, s58
    s_add_u32 s62, s62, 128
    s_cmp_eq_u32 s62, 896
    s_cselect_b32 s62, 128, s62
    s_add_u32 m0, s57, 0
    s_add_u32 s65, s64, 0
    buffer_load_dwordx4 v10, s[40:43], s65 offen lds
    s_add_u32 m0, s57, 1024
    s_add_u32 s65, s64, 7168
    buffer_load_dwordx4 v11, s[40:43], s65 offen lds
    s_waitcnt lgkmcnt(0)
    ds_read_b64_tr_b16 v[52:53], v18 offset:15360
    ds_read_b64_tr_b16 v[54:55], v18 offset:16128
    ds_read_b64_tr_b16 v[56:57], v18 offset:15424
    ds_read_b64_tr_b16 v[58:59], v18 offset:16192
    ds_read_b64_tr_b16 v[60:61], v18 offset:15488
    ds_read_b64_tr_b16 v[62:63], v18 offset:16256
    s_mov_b64 exec, s[60:61]
    ds_read_b128 v[52:55], v22 offset:32
    s_mov_b64 exec, -1
    v_mfma_f32_32x32x16_bf16 v[64:79], v[40:43], v[128:131], v[64:79]
    v_mfma_f32_32x32x16_bf16 v[80:95], v[44:47], v[128:131], v[80:95]
    v_mfma_f32_32x32x16_bf16 v[96:111], v[128:131], v[48:51], v[96:111]
    s_add_u32 m0, s57, 2048
    s_add_u32 s65, s64, 14336
    buffer_load_dwordx4 v10, s[40:43], s65 offen lds
    s_add_u32 m0, s57, 3072
    s_add_u32 s65, s64, 21504
    buffer_load_dwordx4 v11, s[40:43], s65 offen lds
    s_waitcnt lgkmcnt(0)
    ds_read_b64_tr_b16 v[40:41], v18 offset:18432
    ds_read_b64_tr_b16 v[42:43], v18 offset:19200
    ds_read_b64_tr_b16 v[44:45], v18 offset:18496
    ds_read_b64_tr_b16 v[46:47], v18 offset:19264
    ds_read_b64_tr_b16 v[48:49], v18 offset:18560
    ds_read_b64_tr_b16 v[50:51], v18 offset:19328
    s_mov_b64 exec, s[60:61]
    ds_read_b128 v[40:43], v22 offset:64
    s_mov_b64 exec, -1
    v_mfma_f32_32x32x16_bf16 v[64:79], v[52:55], v[132:135], v[64:79]
    v_mfma_f32_32x32x16_bf16 v[80:95], v[56:59], v[132:135], v[80:95]
    v_mfma_f32_32x32x16_bf16 v[96:111], v[132:135], v[60:63], v[96:111]
    s_mov_b64 exec, s[0:1]
    s_add_u32 m0, s59, 135168
    s_add_u32 s65, s63, 0
    buffer_load_dwordx4 v12, s[44:47], s65 offen lds
    s_mov_b64 exec, -1
    s_mov_b64 exec, s[0:1]
    s_add_u32 m0, s59, 141312
    s_add_u32 s65, s63, 86016
    buffer_load_dwordx4 v12, s[44:47], s65 offen lds
    s_mov_b64 exec, -1
    s_waitcnt lgkmcnt(0)
    s_waitcnt vmcnt(6)
    s_barrier
    ds_read_b128 v[24:27], v124
    ds_read_b128 v[28:31], v125
    ds_read_b128 v[32:35], v126
    ds_read_b128 v[36:39], v127
    ds_read_b64_tr_b16 v[52:53], v18 offset:21504
    ds_read_b64_tr_b16 v[54:55], v18 offset:22272
    ds_read_b64_tr_b16 v[56:57], v18 offset:21568
    ds_read_b64_tr_b16 v[58:59], v18 offset:22336
    ds_read_b64_tr_b16 v[60:61], v18 offset:21632
    ds_read_b64_tr_b16 v[62:63], v18 offset:22400
    s_mov_b64 exec, s[60:61]
    ds_read_b128 v[52:55], v22 offset:96
    s_mov_b64 exec, -1
    v_mfma_f32_32x32x16_bf16 v[64:79], v[40:43], v[136:139], v[64:79]
    v_mfma_f32_32x32x16_bf16 v[80:95], v[44:47], v[136:139], v[80:95]
    v_mfma_f32_32x32x16_bf16 v[96:111], v[136:139], v[48:51], v[96:111]
    s_add_u32 s64, s56, s62
    s_mul_i32 s63, s62, 1344
    s_add_u32 s63, s63, s58
    s_add_u32 s62, s62, 128
    s_cmp_eq_u32 s62, 896
    s_cselect_b32 s62, 128, s62
    s_add_u32 m0, s57, 32768
    s_add_u32 s65, s64, 0
    buffer_load_dwordx4 v10, s[40:43], s65 offen lds
    s_add_u32 m0, s57, 33792
    s_add_u32 s65, s64, 7168
    buffer_load_dwordx4 v11, s[40:43], s65 offen lds
    s_waitcnt lgkmcnt(0)
    v_add_u32 v22, s4, v20
    s_add_u32 s4, s4, 128
    s_cmp_eq_u32 s4, 896
    s_cselect_b32 s4, 128, s4
    ds_read_b64_tr_b16 v[40:41], v18 offset:24576
    ds_read_b64_tr_b16 v[42:43], v18 offset:25344
    ds_read_b64_tr_b16 v[44:45], v18 offset:24640
    ds_read_b64_tr_b16 v[46:47], v18 offset:25408
    ds_read_b64_tr_b16 v[48:49], v18 offset:24704
    ds_read_b64_tr_b16 v[50:51], v18 offset:25472
    s_mov_b64 exec, s[60:61]
    ds_read_b128 v[40:43], v22 offset:0
    s_mov_b64 exec, -1
    v_mfma_f32_32x32x16_bf16 v[64:79], v[52:55], v[140:143], v[64:79]
    v_mfma_f32_32x32x16_bf16 v[80:95], v[56:59], v[140:143], v[80:95]
    v_mfma_f32_32x32x16_bf16 v[96:111], v[140:143], v[60:63], v[96:111]
    s_add_u32 m0, s57, 34816
    s_add_u32 s65, s64, 14336
    buffer_load_dwordx4 v10, s[40:43], s65 offen lds
    s_add_u32 m0, s57, 35840
    s_add_u32 s65, s64, 21504
    buffer_load_dwordx4 v11, s[40:43], s65 offen lds
    s_waitcnt lgkmcnt(0)
    ds_read_b64_tr_b16 v[52:53], v18 offset:27648
    ds_read_b64_tr_b16 v[54:55], v18 offset:28416
    ds_read_b64_tr_b16 v[56:57], v18 offset:27712
    ds_read_b64_tr_b16 v[58:59], v18 offset:28480
    ds_read_b64_tr_b16 v[60:61], v18 offset:27776
    ds_read_b64_tr_b16 v[62:63], v18 offset:28544
    s_mov_b64 exec, s[60:61]
    ds_read_b128 v[52:55], v22 offset:32
    s_mov_b64 exec, -1
    v_mfma_f32_32x32x16_bf16 v[64:79], v[40:43], v[24:27], v[64:79]
    v_mfma_f32_32x32x16_bf16 v[80:95], v[44:47], v[24:27], v[80:95]
    v_mfma_f32_32x32x16_bf16 v[96:111], v[24:27], v[48:51], v[96:111]
    s_mov_b64 exec, s[0:1]
    s_add_u32 m0, s59, 98304
    s_add_u32 s65, s63, 0
    buffer_load_dwordx4 v12, s[44:47], s65 offen lds
    s_mov_b64 exec, -1
    s_mov_b64 exec, s[0:1]
    s_add_u32 m0, s59, 104448
    s_add_u32 s65, s63, 86016
    buffer_load_dwordx4 v12, s[44:47], s65 offen lds
    s_mov_b64 exec, -1
    s_waitcnt lgkmcnt(0)
    ds_read_b64_tr_b16 v[40:41], v18 offset:30720
    ds_read_b64_tr_b16 v[42:43], v18 offset:31488
    ds_read_b64_tr_b16 v[44:45], v18 offset:30784
    ds_read_b64_tr_b16 v[46:47], v18 offset:31552
    ds_read_b64_tr_b16 v[48:49], v18 offset:30848
    ds_read_b64_tr_b16 v[50:51], v18 offset:31616
    s_mov_b64 exec, s[60:61]
    ds_read_b128 v[40:43], v22 offset:64
    s_mov_b64 exec, -1
    v_mfma_f32_32x32x16_bf16 v[64:79], v[52:55], v[28:31], v[64:79]
    v_mfma_f32_32x32x16_bf16 v[80:95], v[56:59], v[28:31], v[80:95]
    v_mfma_f32_32x32x16_bf16 v[96:111], v[28:31], v[60:63], v[96:111]
    s_waitcnt lgkmcnt(0)
    s_waitcnt vmcnt(6)
    s_barrier
    ds_read_b128 v[128:131], v14 offset:0
    ds_read_b128 v[132:135], v15 offset:0
    ds_read_b128 v[136:139], v16 offset:0
    ds_read_b128 v[140:143], v17 offset:0
    ds_read_b64_tr_b16 v[52:53], v18 offset:33792
    ds_read_b64_tr_b16 v[54:55], v18 offset:34560
    ds_read_b64_tr_b16 v[56:57], v18 offset:33856
    ds_read_b64_tr_b16 v[58:59], v18 offset:34624
    ds_read_b64_tr_b16 v[60:61], v18 offset:33920
    ds_read_b64_tr_b16 v[62:63], v18 offset:34688
    s_mov_b64 exec, s[60:61]
    ds_read_b128 v[52:55], v22 offset:96
    s_mov_b64 exec, -1
    v_mfma_f32_32x32x16_bf16 v[64:79], v[40:43], v[32:35], v[64:79]
    v_mfma_f32_32x32x16_bf16 v[80:95], v[44:47], v[32:35], v[80:95]
    v_mfma_f32_32x32x16_bf16 v[96:111], v[32:35], v[48:51], v[96:111]
    s_add_u32 s64, s56, s62
    s_mul_i32 s63, s62, 1344
    s_add_u32 s63, s63, s58
    s_add_u32 s62, s62, 128
    s_cmp_eq_u32 s62, 896
    s_cselect_b32 s62, 128, s62
    s_add_u32 m0, s57, 65536
    s_add_u32 s65, s64, 0
    buffer_load_dwordx4 v10, s[40:43], s65 offen lds
    s_add_u32 m0, s57, 66560
    s_add_u32 s65, s64, 7168
    buffer_load_dwordx4 v11, s[40:43], s65 offen lds
    s_waitcnt lgkmcnt(0)
    v_add_u32 v22, s4, v20
    s_add_u32 s4, s4, 128
    s_cmp_eq_u32 s4, 896
    s_cselect_b32 s4, 128, s4
    ds_read_b64_tr_b16 v[40:41], v18 offset:36864
    ds_read_b64_tr_b16 v[42:43], v18 offset:37632
    ds_read_b64_tr_b16 v[44:45], v18 offset:36928
    ds_read_b64_tr_b16 v[46:47], v18 offset:37696
    ds_read_b64_tr_b16 v[48:49], v18 offset:36992
    ds_read_b64_tr_b16 v[50:51], v18 offset:37760
    s_mov_b64 exec, s[60:61]
    ds_read_b128 v[40:43], v22 offset:0
    s_mov_b64 exec, -1
    v_mfma_f32_32x32x16_bf16 v[64:79], v[52:55], v[36:39], v[64:79]
    v_mfma_f32_32x32x16_bf16 v[80:95], v[56:59], v[36:39], v[80:95]
    v_mfma_f32_32x32x16_bf16 v[96:111], v[36:39], v[60:63], v[96:111]
    s_add_u32 m0, s57, 67584
    s_add_u32 s65, s64, 14336
    buffer_load_dwordx4 v10, s[40:43], s65 offen lds
    s_add_u32 m0, s57, 68608
    s_add_u32 s65, s64, 21504
    buffer_load_dwordx4 v11, s[40:43], s65 offen lds
    s_waitcnt lgkmcnt(0)
    ds_read_b64_tr_b16 v[52:53], v18 offset:39936
    ds_read_b64_tr_b16 v[54:55], v18 offset:40704
    ds_read_b64_tr_b16 v[56:57], v18 offset:40000
    ds_read_b64_tr_b16 v[58:59], v18 offset:40768
    ds_read_b64_tr_b16 v[60:61], v18 offset:40064
    ds_read_b64_tr_b16 v[62:63], v18 offset:40832
    s_mov_b64 exec, s[60:61]
    ds_read_b128 v[52:55], v22 offset:32
    s_mov_b64 exec, -1
    v_mfma_f32_32x32x16_bf16 v[64:79], v[40:43], v[128:131], v[64:79]
    v_mfma_f32_32x32x16_bf16 v[80:95], v[44:47], v[128:131], v[80:95]
    v_mfma_f32_32x32x16_bf16 v[96:111], v[128:131], v[48:51], v[96:111]
    s_mov_b64 exec, s[0:1]
    s_add_u32 m0, s59, 110592
    s_add_u32 s65, s63, 0
    buffer_load_dwordx4 v12, s[44:47], s65 offen lds
    s_mov_b64 exec, -1
    s_mov_b64 exec, s[0:1]
    s_add_u32 m0, s59, 116736
    s_add_u32 s65, s63, 86016
    buffer_load_dwordx4 v12, s[44:47], s65 offen lds
    s_mov_b64 exec, -1
    s_waitcnt lgkmcnt(0)
    ds_read_b64_tr_b16 v[40:41], v18 offset:43008
    ds_read_b64_tr_b16 v[42:43], v18 offset:43776
    ds_read_b64_tr_b16 v[44:45], v18 offset:43072
    ds_read_b64_tr_b16 v[46:47], v18 offset:43840
    ds_read_b64_tr_b16 v[48:49], v18 offset:43136
    ds_read_b64_tr_b16 v[50:51], v18 offset:43904
    s_mov_b64 exec, s[60:61]
    ds_read_b128 v[40:43], v22 offset:64
    s_mov_b64 exec, -1
    v_mfma_f32_32x32x16_bf16 v[64:79], v[52:55], v[132:135], v[64:79]
    v_mfma_f32_32x32x16_bf16 v[80:95], v[56:59], v[132:135], v[80:95]
    v_mfma_f32_32x32x16_bf16 v[96:111], v[132:135], v[60:63], v[96:111]
    s_waitcnt lgkmcnt(0)
    s_waitcnt vmcnt(6)
    s_barrier
    ds_read_b128 v[24:27], v14 offset:32768
    ds_read_b128 v[28:31], v15 offset:32768
    ds_read_b128 v[32:35], v16 offset:32768
    ds_read_b128 v[36:39], v17 offset:32768
    ds_read_b64_tr_b16 v[52:53], v18 offset:46080
    ds_read_b64_tr_b16 v[54:55], v18 offset:46848
    ds_read_b64_tr_b16 v[56:57], v18 offset:46144
    ds_read_b64_tr_b16 v[58:59], v18 offset:46912
    ds_read_b64_tr_b16 v[60:61], v18 offset:46208
    ds_read_b64_tr_b16 v[62:63], v18 offset:46976
    s_mov_b64 exec, s[60:61]
    ds_read_b128 v[52:55], v22 offset:96
    s_mov_b64 exec, -1
    v_mfma_f32_32x32x16_bf16 v[64:79], v[40:43], v[136:139], v[64:79]
    v_mfma_f32_32x32x16_bf16 v[80:95], v[44:47], v[136:139], v[80:95]
    v_mfma_f32_32x32x16_bf16 v[96:111], v[136:139], v[48:51], v[96:111]
    s_add_u32 s64, s56, s62
    s_mul_i32 s63, s62, 1344
    s_add_u32 s63, s63, s58
    s_add_u32 s62, s62, 128
    s_cmp_eq_u32 s62, 896
    s_cselect_b32 s62, 128, s62
    s_add_u32 m0, s57, 0
    s_add_u32 s65, s64, 0
    buffer_load_dwordx4 v10, s[40:43], s65 offen lds
    s_add_u32 m0, s57, 1024
    s_add_u32 s65, s64, 7168
    buffer_load_dwordx4 v11, s[40:43], s65 offen lds
    s_waitcnt lgkmcnt(0)
    v_add_u32 v22, s4, v20
    s_add_u32 s4, s4, 128
    s_cmp_eq_u32 s4, 896
    s_cselect_b32 s4, 128, s4
    ds_read_b64_tr_b16 v[40:41], v18 offset:0
    ds_read_b64_tr_b16 v[42:43], v18 offset:768
    ds_read_b64_tr_b16 v[44:45], v18 offset:64
    ds_read_b64_tr_b16 v[46:47], v18 offset:832
    ds_read_b64_tr_b16 v[48:49], v18 offset:128
    ds_read_b64_tr_b16 v[50:51], v18 offset:896
    s_mov_b64 exec, s[60:61]
    ds_read_b128 v[40:43], v22 offset:0
    s_mov_b64 exec, -1
    v_mfma_f32_32x32x16_bf16 v[64:79], v[52:55], v[140:143], v[64:79]
    v_mfma_f32_32x32x16_bf16 v[80:95], v[56:59], v[140:143], v[80:95]
    v_mfma_f32_32x32x16_bf16 v[96:111], v[140:143], v[60:63], v[96:111]
    s_add_u32 m0, s57, 2048
    s_add_u32 s65, s64, 14336
    buffer_load_dwordx4 v10, s[40:43], s65 offen lds
    s_add_u32 m0, s57, 3072
    s_add_u32 s65, s64, 21504
    buffer_load_dwordx4 v11, s[40:43], s65 offen lds
    s_waitcnt lgkmcnt(0)
    ds_read_b64_tr_b16 v[52:53], v18 offset:3072
    ds_read_b64_tr_b16 v[54:55], v18 offset:3840
    ds_read_b64_tr_b16 v[56:57], v18 offset:3136
    ds_read_b64_tr_b16 v[58:59], v18 offset:3904
    ds_read_b64_tr_b16 v[60:61], v18 offset:3200
    ds_read_b64_tr_b16 v[62:63], v18 offset:3968
    s_mov_b64 exec, s[60:61]
    ds_read_b128 v[52:55], v22 offset:32
    s_mov_b64 exec, -1
    v_mfma_f32_32x32x16_bf16 v[64:79], v[40:43], v[24:27], v[64:79]
    v_mfma_f32_32x32x16_bf16 v[80:95], v[44:47], v[24:27], v[80:95]
    v_mfma_f32_32x32x16_bf16 v[96:111], v[24:27], v[48:51], v[96:111]
    s_mov_b64 exec, s[0:1]
    s_add_u32 m0, s59, 122880
    s_add_u32 s65, s63, 0
    buffer_load_dwordx4 v12, s[44:47], s65 offen lds
    s_mov_b64 exec, -1
    s_mov_b64 exec, s[0:1]
    s_add_u32 m0, s59, 129024
    s_add_u32 s65, s63, 86016
    buffer_load_dwordx4 v12, s[44:47], s65 offen lds
    s_mov_b64 exec, -1
    s_waitcnt lgkmcnt(0)
    ds_read_b64_tr_b16 v[40:41], v18 offset:6144
    ds_read_b64_tr_b16 v[42:43], v18 offset:6912
    ds_read_b64_tr_b16 v[44:45], v18 offset:6208
    ds_read_b64_tr_b16 v[46:47], v18 offset:6976
    ds_read_b64_tr_b16 v[48:49], v18 offset:6272
    ds_read_b64_tr_b16 v[50:51], v18 offset:7040
    s_mov_b64 exec, s[60:61]
    ds_read_b128 v[40:43], v22 offset:64
    s_mov_b64 exec, -1
    v_mfma_f32_32x32x16_bf16 v[64:79], v[52:55], v[28:31], v[64:79]
    v_mfma_f32_32x32x16_bf16 v[80:95], v[56:59], v[28:31], v[80:95]
    v_mfma_f32_32x32x16_bf16 v[96:111], v[28:31], v[60:63], v[96:111]
    s_waitcnt lgkmcnt(0)
    s_waitcnt vmcnt(6)
    s_barrier
    ds_read_b128 v[128:131], v124
    ds_read_b128 v[132:135], v125
    ds_read_b128 v[136:139], v126
    ds_read_b128 v[140:143], v127
    ds_read_b64_tr_b16 v[52:53], v18 offset:9216
    ds_read_b64_tr_b16 v[54:55], v18 offset:9984
    ds_read_b64_tr_b16 v[56:57], v18 offset:9280
    ds_read_b64_tr_b16 v[58:59], v18 offset:10048
    ds_read_b64_tr_b16 v[60:61], v18 offset:9344
    ds_read_b64_tr_b16 v[62:63], v18 offset:10112
    s_mov_b64 exec, s[60:61]
    ds_read_b128 v[52:55], v22 offset:96
    s_mov_b64 exec, -1
    v_mfma_f32_32x32x16_bf16 v[64:79], v[40:43], v[32:35], v[64:79]
    v_mfma_f32_32x32x16_bf16 v[80:95], v[44:47], v[32:35], v[80:95]
    v_mfma_f32_32x32x16_bf16 v[96:111], v[32:35], v[48:51], v[96:111]
    s_waitcnt lgkmcnt(0)
    v_add_u32 v22, s4, v20
    s_add_u32 s4, s4, 128
    s_cmp_eq_u32 s4, 896
    s_cselect_b32 s4, 128, s4
    ds_read_b64_tr_b16 v[40:41], v18 offset:12288
    ds_read_b64_tr_b16 v[42:43], v18 offset:13056
    ds_read_b64_tr_b16 v[44:45], v18 offset:12352
    ds_read_b64_tr_b16 v[46:47], v18 offset:13120
    ds_read_b64_tr_b16 v[48:49], v18 offset:12416
    ds_read_b64_tr_b16 v[50:51], v18 offset:13184
    s_mov_b64 exec, s[60:61]
    ds_read_b128 v[40:43], v22 offset:0
    s_mov_b64 exec, -1
    v_mfma_f32_32x32x16_bf16 v[64:79], v[52:55], v[36:39], v[64:79]
    v_mfma_f32_32x32x16_bf16 v[80:95], v[56:59], v[36:39], v[80:95]
    v_mfma_f32_32x32x16_bf16 v[96:111], v[36:39], v[60:63], v[96:111]
    s_waitcnt lgkmcnt(0)
    ds_read_b64_tr_b16 v[52:53], v18 offset:15360
    ds_read_b64_tr_b16 v[54:55], v18 offset:16128
    ds_read_b64_tr_b16 v[56:57], v18 offset:15424
    ds_read_b64_tr_b16 v[58:59], v18 offset:16192
    ds_read_b64_tr_b16 v[60:61], v18 offset:15488
    ds_read_b64_tr_b16 v[62:63], v18 offset:16256
    s_mov_b64 exec, s[60:61]
    ds_read_b128 v[52:55], v22 offset:32
    s_mov_b64 exec, -1
    v_mfma_f32_32x32x16_bf16 v[64:79], v[40:43], v[128:131], v[64:79]
    v_mfma_f32_32x32x16_bf16 v[80:95], v[44:47], v[128:131], v[80:95]
    v_mfma_f32_32x32x16_bf16 v[96:111], v[128:131], v[48:51], v[96:111]
    s_waitcnt lgkmcnt(0)
    ds_read_b64_tr_b16 v[40:41], v18 offset:18432
    ds_read_b64_tr_b16 v[42:43], v18 offset:19200
    ds_read_b64_tr_b16 v[44:45], v18 offset:18496
    ds_read_b64_tr_b16 v[46:47], v18 offset:19264
    ds_read_b64_tr_b16 v[48:49], v18 offset:18560
    ds_read_b64_tr_b16 v[50:51], v18 offset:19328
    s_mov_b64 exec, s[60:61]
    ds_read_b128 v[40:43], v22 offset:64
    s_mov_b64 exec, -1
    v_mfma_f32_32x32x16_bf16 v[64:79], v[52:55], v[132:135], v[64:79]
    v_mfma_f32_32x32x16_bf16 v[80:95], v[56:59], v[132:135], v[80:95]
    v_mfma_f32_32x32x16_bf16 v[96:111], v[132:135], v[60:63], v[96:111]
    s_waitcnt lgkmcnt(0)
    s_waitcnt vmcnt(0)
    v_mov_b32 v120, 0
    buffer_load_dword v121, v120, s[12:15], 0 offen sc1
    s_barrier
    ds_read_b128 v[24:27], v14 offset:0
    ds_read_b128 v[28:31], v15 offset:0
    ds_read_b128 v[32:35], v16 offset:0
    ds_read_b128 v[36:39], v17 offset:0
    ds_read_b64_tr_b16 v[52:53], v18 offset:21504
    ds_read_b64_tr_b16 v[54:55], v18 offset:22272
    ds_read_b64_tr_b16 v[56:57], v18 offset:21568
    ds_read_b64_tr_b16 v[58:59], v18 offset:22336
    ds_read_b64_tr_b16 v[60:61], v18 offset:21632
    ds_read_b64_tr_b16 v[62:63], v18 offset:22400
    s_mov_b64 exec, s[60:61]
    ds_read_b128 v[52:55], v22 offset:96
    s_mov_b64 exec, -1
    v_mfma_f32_32x32x16_bf16 v[64:79], v[40:43], v[136:139], v[64:79]
    v_mfma_f32_32x32x16_bf16 v[80:95], v[44:47], v[136:139], v[80:95]
    v_mfma_f32_32x32x16_bf16 v[96:111], v[136:139], v[48:51], v[96:111]
    s_waitcnt lgkmcnt(0)
    v_add_u32 v22, s4, v20
    s_add_u32 s4, s4, 128
    s_cmp_eq_u32 s4, 896
    s_cselect_b32 s4, 128, s4
    ds_read_b64_tr_b16 v[40:41], v18 offset:24576
    ds_read_b64_tr_b16 v[42:43], v18 offset:25344
    ds_read_b64_tr_b16 v[44:45], v18 offset:24640
    ds_read_b64_tr_b16 v[46:47], v18 offset:25408
    ds_read_b64_tr_b16 v[48:49], v18 offset:24704
    ds_read_b64_tr_b16 v[50:51], v18 offset:25472
    s_mov_b64 exec, s[60:61]
    ds_read_b128 v[40:43], v22 offset:0
    s_mov_b64 exec, -1
    v_mfma_f32_32x32x16_bf16 v[64:79], v[52:55], v[140:143], v[64:79]
    v_mfma_f32_32x32x16_bf16 v[80:95], v[56:59], v[140:143], v[80:95]
    v_mfma_f32_32x32x16_bf16 v[96:111], v[140:143], v[60:63], v[96:111]
    s_waitcnt lgkmcnt(0)
    ds_read_b64_tr_b16 v[52:53], v18 offset:27648
    ds_read_b64_tr_b16 v[54:55], v18 offset:28416
    ds_read_b64_tr_b16 v[56:57], v18 offset:27712
    ds_read_b64_tr_b16 v[58:59], v18 offset:28480
    ds_read_b64_tr_b16 v[60:61], v18 offset:27776
    ds_read_b64_tr_b16 v[62:63], v18 offset:28544
    s_mov_b64 exec, s[60:61]
    ds_read_b128 v[52:55], v22 offset:32
    s_mov_b64 exec, -1
    v_mfma_f32_32x32x16_bf16 v[64:79], v[40:43], v[24:27], v[64:79]
    v_mfma_f32_32x32x16_bf16 v[80:95], v[44:47], v[24:27], v[80:95]
    v_mfma_f32_32x32x16_bf16 v[96:111], v[24:27], v[48:51], v[96:111]
    s_waitcnt lgkmcnt(0)
    ds_read_b64_tr_b16 v[40:41], v18 offset:30720
    ds_read_b64_tr_b16 v[42:43], v18 offset:31488
    ds_read_b64_tr_b16 v[44:45], v18 offset:30784
    ds_read_b64_tr_b16 v[46:47], v18 offset:31552
    ds_read_b64_tr_b16 v[48:49], v18 offset:30848
    ds_read_b64_tr_b16 v[50:51], v18 offset:31616
    s_mov_b64 exec, s[60:61]
    ds_read_b128 v[40:43], v22 offset:64
    s_mov_b64 exec, -1
    v_mfma_f32_32x32x16_bf16 v[64:79], v[52:55], v[28:31], v[64:79]
    v_mfma_f32_32x32x16_bf16 v[80:95], v[56:59], v[28:31], v[80:95]
    v_mfma_f32_32x32x16_bf16 v[96:111], v[28:31], v[60:63], v[96:111]
    s_waitcnt lgkmcnt(0)
    ds_read_b64_tr_b16 v[52:53], v18 offset:33792
    ds_read_b64_tr_b16 v[54:55], v18 offset:34560
    ds_read_b64_tr_b16 v[56:57], v18 offset:33856
    ds_read_b64_tr_b16 v[58:59], v18 offset:34624
    ds_read_b64_tr_b16 v[60:61], v18 offset:33920
    ds_read_b64_tr_b16 v[62:63], v18 offset:34688
    s_mov_b64 exec, s[60:61]
    ds_read_b128 v[52:55], v22 offset:96
    s_mov_b64 exec, -1
    v_mfma_f32_32x32x16_bf16 v[64:79], v[40:43], v[32:35], v[64:79]
    v_mfma_f32_32x32x16_bf16 v[80:95], v[44:47], v[32:35], v[80:95]
    v_mfma_f32_32x32x16_bf16 v[96:111], v[32:35], v[48:51], v[96:111]
    s_waitcnt lgkmcnt(0)
    v_mfma_f32_32x32x16_bf16 v[64:79], v[52:55], v[36:39], v[64:79]
    v_mfma_f32_32x32x16_bf16 v[80:95], v[56:59], v[36:39], v[80:95]
    v_mfma_f32_32x32x16_bf16 v[96:111], v[36:39], v[60:63], v[96:111]
    s_mov_b32 s52, s34
    s_mov_b32 s53, s35
    s_mov_b32 s54, 18874368
    s_mov_b32 s55, 0x20000
    s_lshl_b32 s11, s10, 12
    s_mov_b32 s67, 0x3e8b97f6
    s_mov_b32 s68, 0
    s_mov_b32 s69, -1
    s_mov_b32 s70, 0xf0000000
    s_mov_b32 s71, 0xf0000000
    s_nop 7
    v_cvt_pk_bf16_f32 v80, v80, v81
    v_cvt_pk_bf16_f32 v81, v82, v83
    v_cvt_pk_bf16_f32 v82, v84, v85
    v_cvt_pk_bf16_f32 v83, v86, v87
    v_cvt_pk_bf16_f32 v84, v88, v89
    v_cvt_pk_bf16_f32 v85, v90, v91
    v_cvt_pk_bf16_f32 v86, v92, v93
    v_cvt_pk_bf16_f32 v87, v94, v95
    v_cvt_pk_bf16_f32 v96, v96, v97
    v_cvt_pk_bf16_f32 v97, v98, v99
    v_cvt_pk_bf16_f32 v98, v100, v101
    v_cvt_pk_bf16_f32 v99, v102, v103
    v_cvt_pk_bf16_f32 v100, v104, v105
    v_cvt_pk_bf16_f32 v101, v106, v107
    v_cvt_pk_bf16_f32 v102, v108, v109
    v_cvt_pk_bf16_f32 v103, v110, v111
    s_mov_b64 exec, s[68:69]
    v_mov_b32 v86, 0x3f80
    v_mov_b32 v87, 0
    s_mov_b64 exec, s[70:71]
    v_mov_b32 v96, v21
    v_mov_b32 v97, v21
    v_mov_b32 v98, v21
    v_mov_b32 v99, v21
    v_mov_b32 v100, v21
    v_mov_b32 v101, v21
    v_mov_b32 v102, v21
    v_mov_b32 v103, v21
    s_mov_b64 exec, -1
    s_lshl_b32 s3, s9, 12
    v_add_u32 v5, s3, v2
    buffer_store_dwordx4 v[80:83], v2, s[36:39], s11 offen offset:0 sc1
    buffer_store_dwordx4 v[84:87], v2, s[36:39], s11 offen offset:1024 sc1
    buffer_store_dwordx4 v[96:99], v2, s[36:39], s11 offen offset:2048 sc1
    buffer_store_dwordx4 v[100:103], v2, s[36:39], s11 offen offset:3072 sc1
    v_mul_f32 v6, 0xbfb8aa3b, v76
    v_exp_f32 v6, v6
    s_nop 0
    v_add_f32 v6, 1.0, v6
    v_rcp_f32 v6, v6
    s_nop 0
    v_sub_f32 v7, 1.0, v6
    s_cmp_eq_u32 s7, 0
    s_cselect_b64 vcc, -1, 0
    v_cndmask_b32 v6, v7, v6, vcc
    v_mul_f32 v64, s67, v64
    v_mul_f32 v65, s67, v65
    v_mul_f32 v66, s67, v66
    v_mul_f32 v67, s67, v67
    v_mul_f32 v68, s67, v68
    v_mul_f32 v69, s67, v69
    v_mul_f32 v70, s67, v70
    v_mul_f32 v71, s67, v71
    v_mul_f32 v72, s67, v72
    v_mul_f32 v73, s67, v73
    v_mul_f32 v74, s67, v74
    v_mul_f32 v75, s67, v75
    v_mul_f32 v76, s67, v76
    v_mul_f32 v77, s67, v77
    v_mul_f32 v78, s67, v78
    v_mul_f32 v79, s67, v79
    v_cvt_pk_bf16_f32 v64, v64, v65
    v_cvt_pk_bf16_f32 v65, v66, v67
    v_cvt_pk_bf16_f32 v66, v68, v69
    v_cvt_pk_bf16_f32 v67, v70, v71
    v_cvt_pk_bf16_f32 v68, v72, v73
    v_cvt_pk_bf16_f32 v69, v74, v75
    v_cvt_pk_bf16_f32 v70, v76, v77
    v_cvt_pk_bf16_f32 v71, v78, v79
    s_lshl_b32 s3, s9, 11
    s_add_u32 s3, s3, 65536
    v_add_u32 v7, s3, v2
    s_lshl_b32 s3, s9, 7
    s_add_u32 s3, s3, 157568
    v_lshl_add_u32 v8, v1, 2, s3
    s_mov_b64 exec, s[68:69]
    v_mov_b32 v70, 0
    v_mov_b32 v71, 0
    s_mov_b64 exec, -1
    s_nop 0
    v_mfma_f32_32x32x16_bf16 v[32:47], v[80:83], v[64:67], 0
    v_mfma_f32_32x32x16_bf16 v[32:47], v[84:87], v[68:71], v[32:47]
    ds_write_b128 v5, v[80:83] offset:0
    ds_write_b128 v5, v[84:87] offset:1024
    ds_write_b128 v5, v[96:99] offset:2048
    ds_write_b128 v5, v[100:103] offset:3072
    ds_write_b128 v7, v[64:67]
    s_nop 7
    v_max3_f32 v9, v32, v33, v34
    v_max3_f32 v9, v9, v35, v36
    v_max3_f32 v9, v9, v37, v38
    v_max3_f32 v9, v9, v39, v40
    v_max3_f32 v9, v9, v41, v42
    v_max3_f32 v9, v9, v43, v44
    v_max3_f32 v9, v9, v45, v46
    v_max_f32 v9, v9, v47
    s_nop 0
    v_mov_b32 v13, v9
    s_nop 1
    v_permlane32_swap_b32 v9, v13
    s_nop 1
    v_max_f32 v9, v9, v13
    v_lshrrev_b32 v9, 16, v9
    v_xor_b32 v9, 0x8000, v9
    s_mov_b64 exec, s[68:69]
    v_mov_b32 v70, v9
    s_mov_b64 exec, -1
    ds_write_b128 v7, v[68:71] offset:1024
    s_mov_b64 exec, s[68:69]
    ds_write_b32 v8, v6
    s_mov_b64 exec, -1
    v_mov_b32 v123, 158720
    v_mov_b32 v6, 0
    ds_write_b32 v123, v6
    s_and_b32 s62, s9, 3
    s_lshr_b32 s63, s9, 2
    s_lshl_b32 s64, s62, 1
    s_add_u32 s64, s64, s63
    s_lshl_b32 s3, s63, 14
    v_add_u32 v9, s3, v2
    v_add_u32 v13, 65536, v9
    s_lshl_b32 s57, s9, 10
    v_lshlrev_b32 v10, 7, v1
    s_lshl_b32 s61, s5, 10
    s_add_u32 s61, s61, 16777216
    s_lshl_b32 s58, 1, s6
    s_xor_b32 s58, s58, 0xff
    s_mov_b32 s59, 0
    s_waitcnt lgkmcnt(0)
    s_barrier
    s_lshl_b32 s3, s64, 11
    s_add_u32 s3, s3, 65536
    v_add_u32 v5, s3, v2
    v_xor_b32 v6, 2048, v5
    ds_read_b128 v[16:19], v5
    ds_read_b128 v[20:23], v5 offset:1024
    ds_read_b128 v[24:27], v6
    ds_read_b128 v[28:31], v6 offset:1024
    s_lshl_b32 s3, s64, 7
    s_add_u32 s3, s3, 157696
    v_and_b32 v7, 31, v1
    v_lshl_add_u32 v7, v7, 2, s3
    ds_read_b32 v4, v7
    ds_read_b128 v[72:75], v9 offset:0
    ds_read_b128 v[76:79], v9 offset:1024
    ds_read_b128 v[80:83], v9 offset:2048
    v_mov_b32 v88, 0
    v_mov_b32 v89, 0
    v_mov_b32 v90, 0
    v_mov_b32 v91, 0
    v_mov_b32 v92, 0
    v_mov_b32 v93, 0
    v_mov_b32 v94, 0
    v_mov_b32 v95, 0
    v_mov_b32 v96, 0
    v_mov_b32 v97, 0
    v_mov_b32 v98, 0
    v_mov_b32 v99, 0
    v_mov_b32 v100, 0
    v_mov_b32 v101, 0
    v_mov_b32 v102, 0
    v_mov_b32 v103, 0
    v_mov_b32 v104, 0
    v_mov_b32 v105, 0
    v_mov_b32 v106, 0
    v_mov_b32 v107, 0
    v_mov_b32 v108, 0
    v_mov_b32 v109, 0
    v_mov_b32 v110, 0
    v_mov_b32 v111, 0
    v_mov_b32 v112, 0
    v_mov_b32 v113, 0
    v_mov_b32 v114, 0
    v_mov_b32 v115, 0
    v_mov_b32 v116, 0
    v_mov_b32 v117, 0
    v_mov_b32 v118, 0
    v_mov_b32 v119, 0
    s_mov_b64 s[62:63], 0
    s_waitcnt lgkmcnt(0)
    v_mfma_f32_32x32x16_bf16 v[32:47], v[72:75], v[16:19], 0
    v_mfma_f32_32x32x16_bf16 v[32:47], v[76:79], v[20:23], v[32:47]
    s_nop 7
    s_nop 3
    s_mul_i32 s3, s5, 37
    s_lshr_b32 s4, s3, 8
    s_mul_i32 s3, s4, 7
    s_sub_u32 s3, s5, s3
    s_lshl_b32 s11, s6, 2
    s_add_u32 s4, s4, s11
    s_lshl_b32 s56, s3, 7
    v_lshrrev_b32 v6, 3, v1
    v_mul_u32_u24 v6, 896, v6
    v_and_b32 v7, 7, v1
    v_bfe_u32 v5, v1, 4, 1
    v_lshlrev_b32 v5, 2, v5
    v_xor_b32 v7, v7, v5
    v_lshl_add_u32 v15, v7, 4, v6
    s_mov_b32 s40, s20
    s_mov_b32 s41, s21
    s_mov_b32 s42, 401408
    s_mov_b32 s43, 0x20000
    s_mov_b32 s44, s26
    s_mov_b32 s45, s27
    s_mov_b32 s46, 401408
    s_mov_b32 s47, 0x20000
    s_mov_b32 s48, s30
    s_mov_b32 s49, s31
    s_mov_b32 s50, 1835008
    s_mov_b32 s51, 0x20000
    s_waitcnt vmcnt(0)
    s_barrier
    s_mov_b32 s65, 0
F_tag:
    v_readfirstlane_b32 s71, v121
    s_add_u32 s65, s65, 1
    s_nop 2
    s_cmp_lg_u32 s71, 0
    s_cbranch_scc1 F_tagok
    s_cmp_gt_u32 s65, 0x200000
    s_cbranch_scc1 F_tagok
    s_sleep 2
    buffer_load_dword v121, v120, s[12:15], 0 offen sc1
    s_waitcnt vmcnt(0)
    s_branch F_tag
F_tagok:
    s_cmp_lg_u32 s9, 0
    s_cbranch_scc1 F_nsig
    s_lshl_b32 s3, s6, 7
    s_add_u32 s3, s3, s61
    v_mov_b32 v12, s71
    s_mov_b64 exec, 1
    buffer_store_dword v12, v120, s[52:55], s3 offen sc1
    s_mov_b64 exec, -1
F_nsig:
    s_setprio 3
    v_mfma_f32_32x32x16_bf16 v[48:63], v[72:75], v[24:27], 0
    ds_read_b128 v[72:75], v9 offset:4096
    v_exp_f32 v32, v32
    v_exp_f32 v33, v33
    v_exp_f32 v34, v34
    v_exp_f32 v35, v35
    v_cvt_pk_bf16_f32 v64, v32, v33
    v_cvt_pk_bf16_f32 v65, v34, v35
    v_mfma_f32_32x32x16_bf16 v[48:63], v[76:79], v[28:31], v[48:63]
    ds_read_b128 v[76:79], v9 offset:5120
    v_exp_f32 v36, v36
    v_exp_f32 v37, v37
    v_exp_f32 v38, v38
    v_exp_f32 v39, v39
    v_cvt_pk_bf16_f32 v66, v36, v37
    v_cvt_pk_bf16_f32 v67, v38, v39
    ds_read_b128 v[84:87], v9 offset:3072
    v_exp_f32 v40, v40
    v_exp_f32 v41, v41
    v_exp_f32 v42, v42
    v_exp_f32 v43, v43
    v_cvt_pk_bf16_f32 v68, v40, v41
    v_cvt_pk_bf16_f32 v69, v42, v43
    v_mfma_f32_32x32x16_bf16 v[88:103], v[80:83], v[64:67], v[88:103]
    v_exp_f32 v44, v44
    v_exp_f32 v45, v45
    v_exp_f32 v46, v46
    v_exp_f32 v47, v47
    s_waitcnt lgkmcnt(2)
    s_setprio 3
    v_cvt_pk_bf16_f32 v70, v44, v45
    v_cvt_pk_bf16_f32 v71, v46, v47
    s_cmp_lg_u32 s9, 0
    s_cbranch_scc1 F_npi
    s_mov_b64 exec, s[58:59]
    buffer_load_dword v12, v10, s[52:55], s61 offen sc1
    s_mov_b64 exec, -1
F_npi:
    v_mfma_f32_32x32x16_bf16 v[32:47], v[72:75], v[16:19], 0
    v_exp_f32 v48, v48
    v_exp_f32 v49, v49
    v_exp_f32 v50, v50
    v_exp_f32 v51, v51
    s_waitcnt lgkmcnt(1)
    v_cvt_pk_bf16_f32 v64, v48, v49
    v_cvt_pk_bf16_f32 v65, v50, v51
    v_mfma_f32_32x32x16_bf16 v[32:47], v[76:79], v[20:23], v[32:47]
    v_exp_f32 v52, v52
    v_exp_f32 v53, v53
    v_exp_f32 v54, v54
    v_exp_f32 v55, v55
    s_waitcnt lgkmcnt(0)
    v_cvt_pk_bf16_f32 v66, v52, v53
    v_cvt_pk_bf16_f32 v67, v54, v55
    v_mfma_f32_32x32x16_bf16 v[88:103], v[84:87], v[68:71], v[88:103]
    v_exp_f32 v56, v56
    v_exp_f32 v57, v57
    v_exp_f32 v58, v58
    v_exp_f32 v59, v59
    v_cvt_pk_bf16_f32 v68, v56, v57
    v_cvt_pk_bf16_f32 v69, v58, v59
    v_mfma_f32_32x32x16_bf16 v[104:119], v[80:83], v[64:67], v[104:119]
    ds_read_b128 v[80:83], v9 offset:6144
    v_exp_f32 v60, v60
    v_exp_f32 v61, v61
    v_exp_f32 v62, v62
    v_exp_f32 v63, v63
    s_setprio 2
    v_cvt_pk_bf16_f32 v70, v60, v61
    v_cvt_pk_bf16_f32 v71, v62, v63
    v_mfma_f32_32x32x16_bf16 v[48:63], v[72:75], v[24:27], 0
    ds_read_b128 v[72:75], v9 offset:8192
    v_exp_f32 v32, v32
    v_exp_f32 v33, v33
    v_exp_f32 v34, v34
    v_exp_f32 v35, v35
    v_cvt_pk_bf16_f32 v64, v32, v33
    v_cvt_pk_bf16_f32 v65, v34, v35
    v_mfma_f32_32x32x16_bf16 v[48:63], v[76:79], v[28:31], v[48:63]
    ds_read_b128 v[76:79], v9 offset:9216
    v_exp_f32 v36, v36
    v_exp_f32 v37, v37
    v_exp_f32 v38, v38
    v_exp_f32 v39, v39
    v_cvt_pk_bf16_f32 v66, v36, v37
    v_cvt_pk_bf16_f32 v67, v38, v39
    v_mfma_f32_32x32x16_bf16 v[104:119], v[84:87], v[68:71], v[104:119]
    ds_read_b128 v[84:87], v9 offset:7168
    v_exp_f32 v40, v40
    v_exp_f32 v41, v41
    v_exp_f32 v42, v42
    v_exp_f32 v43, v43
    s_waitcnt lgkmcnt(3)
    v_cvt_pk_bf16_f32 v68, v40, v41
    v_cvt_pk_bf16_f32 v69, v42, v43
    v_mfma_f32_32x32x16_bf16 v[88:103], v[80:83], v[64:67], v[88:103]
    v_exp_f32 v44, v44
    v_exp_f32 v45, v45
    v_exp_f32 v46, v46
    v_exp_f32 v47, v47
    s_waitcnt lgkmcnt(2)
    s_setprio 1
    v_cvt_pk_bf16_f32 v70, v44, v45
    v_cvt_pk_bf16_f32 v71, v46, v47
    s_cmp_lg_u32 s9, 0
    s_cbranch_scc1 F_npc
    s_mov_b64 exec, s[58:59]
    s_mov_b32 s65, 0
    s_branch F_pchkkv
F_pollkv:
    buffer_load_dword v12, v10, s[52:55], s61 offen sc1
F_pchkkv:
    s_waitcnt vmcnt(0)
    v_cmp_ne_u32 vcc, s71, v12
    s_add_u32 s65, s65, 1
    s_nop 0
    s_cmp_eq_u64 vcc, 0
    s_cbranch_scc1 F_pdonekv
    s_cmp_gt_u32 s65, 0x200000
    s_cbranch_scc1 F_pdonekv
    s_mov_b64 exec, vcc
    s_sleep 1
    s_branch F_pollkv
F_pdonekv:
    s_mov_b64 exec, -1
    v_mov_b32 v12, 1
    ds_write_b32 v123, v12
F_npc:
    s_mov_b32 s60, 0
    s_cmp_lg_u32 s60, 0
    s_cbranch_scc1 F_go3x
F_go3:
    ds_read_b32 v12, v123
    s_waitcnt lgkmcnt(0)
    v_readfirstlane_b32 s60, v12
    s_nop 3
    s_cmp_lg_u32 s60, 0
    s_cbranch_scc0 F_go3x
    s_add_u32 s70, s6, 1
    s_and_b32 s70, s70, 7
    s_lshl_b32 s70, s70, 15
    s_add_u32 m0, s57, 32768
    s_add_u32 s65, s70, 0
    buffer_load_dwordx4 v3, s[36:39], s65 offen sc1 lds
    s_add_u32 m0, s57, 40960
    s_add_u32 s65, s70, 8192
    buffer_load_dwordx4 v3, s[36:39], s65 offen sc1 lds
    s_add_u32 m0, s57, 49152
    s_add_u32 s65, s70, 16384
    buffer_load_dwordx4 v3, s[36:39], s65 offen sc1 lds
    s_add_u32 m0, s57, 57344
    s_add_u32 s65, s70, 24576
    buffer_load_dwordx4 v3, s[36:39], s65 offen sc1 lds
F_go3x:
    v_mfma_f32_32x32x16_bf16 v[32:47], v[72:75], v[16:19], 0
    v_exp_f32 v48, v48
    v_exp_f32 v49, v49
    v_exp_f32 v50, v50
    v_exp_f32 v51, v51
    s_waitcnt lgkmcnt(1)
    v_cvt_pk_bf16_f32 v64, v48, v49
    v_cvt_pk_bf16_f32 v65, v50, v51
    v_mfma_f32_32x32x16_bf16 v[32:47], v[76:79], v[20:23], v[32:47]
    v_exp_f32 v52, v52
    v_exp_f32 v53, v53
    v_exp_f32 v54, v54
    v_exp_f32 v55, v55
    s_waitcnt lgkmcnt(0)
    v_cvt_pk_bf16_f32 v66, v52, v53
    v_cvt_pk_bf16_f32 v67, v54, v55
    v_mfma_f32_32x32x16_bf16 v[88:103], v[84:87], v[68:71], v[88:103]
    v_exp_f32 v56, v56
    v_exp_f32 v57, v57
    v_exp_f32 v58, v58
    v_exp_f32 v59, v59
    v_cvt_pk_bf16_f32 v68, v56, v57
    v_cvt_pk_bf16_f32 v69, v58, v59
    v_mfma_f32_32x32x16_bf16 v[104:119], v[80:83], v[64:67], v[104:119]
    ds_read_b128 v[80:83], v9 offset:10240
    v_exp_f32 v60, v60
    v_exp_f32 v61, v61
    v_exp_f32 v62, v62
    v_exp_f32 v63, v63
    s_setprio 1
    v_cvt_pk_bf16_f32 v70, v60, v61
    v_cvt_pk_bf16_f32 v71, v62, v63
    s_cmp_lg_u32 s60, 0
    s_cbranch_scc1 F_go4x
F_go4:
    ds_read_b32 v12, v123
    s_waitcnt lgkmcnt(0)
    v_readfirstlane_b32 s60, v12
    s_nop 3
    s_cmp_lg_u32 s60, 0
    s_cbranch_scc0 F_go4
    s_add_u32 s70, s6, 1
    s_and_b32 s70, s70, 7
    s_lshl_b32 s70, s70, 15
    s_add_u32 m0, s57, 32768
    s_add_u32 s65, s70, 0
    buffer_load_dwordx4 v3, s[36:39], s65 offen sc1 lds
    s_add_u32 m0, s57, 40960
    s_add_u32 s65, s70, 8192
    buffer_load_dwordx4 v3, s[36:39], s65 offen sc1 lds
    s_add_u32 m0, s57, 49152
    s_add_u32 s65, s70, 16384
    buffer_load_dwordx4 v3, s[36:39], s65 offen sc1 lds
    s_add_u32 m0, s57, 57344
    s_add_u32 s65, s70, 24576
    buffer_load_dwordx4 v3, s[36:39], s65 offen sc1 lds
F_go4x:
    v_mfma_f32_32x32x16_bf16 v[48:63], v[72:75], v[24:27], 0
    ds_read_b128 v[72:75], v9 offset:12288
    v_exp_f32 v32, v32
    v_exp_f32 v33, v33
    v_exp_f32 v34, v34
    v_exp_f32 v35, v35
    v_cvt_pk_bf16_f32 v64, v32, v33
    v_cvt_pk_bf16_f32 v65, v34, v35
    v_mfma_f32_32x32x16_bf16 v[48:63], v[76:79], v[28:31], v[48:63]
    ds_read_b128 v[76:79], v9 offset:13312
    v_exp_f32 v36, v36
    v_exp_f32 v37, v37
    v_exp_f32 v38, v38
    v_exp_f32 v39, v39
    v_cvt_pk_bf16_f32 v66, v36, v37
    v_cvt_pk_bf16_f32 v67, v38, v39
    v_mfma_f32_32x32x16_bf16 v[104:119], v[84:87], v[68:71], v[104:119]
    ds_read_b128 v[84:87], v9 offset:11264
    v_exp_f32 v40, v40
    v_exp_f32 v41, v41
    v_exp_f32 v42, v42
    v_exp_f32 v43, v43
    s_waitcnt lgkmcnt(3)
    v_cvt_pk_bf16_f32 v68, v40, v41
    v_cvt_pk_bf16_f32 v69, v42, v43
    v_mfma_f32_32x32x16_bf16 v[88:103], v[80:83], v[64:67], v[88:103]
    v_exp_f32 v44, v44
    v_exp_f32 v45, v45
    v_exp_f32 v46, v46
    v_exp_f32 v47, v47
    s_waitcnt lgkmcnt(2)
    s_setprio 0
    v_cvt_pk_bf16_f32 v70, v44, v45
    v_cvt_pk_bf16_f32 v71, v46, v47
    v_mfma_f32_32x32x16_bf16 v[32:47], v[72:75], v[16:19], 0
    v_exp_f32 v48, v48
    v_exp_f32 v49, v49
    v_exp_f32 v50, v50
    v_exp_f32 v51, v51
    s_waitcnt lgkmcnt(1)
    v_cvt_pk_bf16_f32 v64, v48, v49
    v_cvt_pk_bf16_f32 v65, v50, v51
    v_mfma_f32_32x32x16_bf16 v[32:47], v[76:79], v[20:23], v[32:47]
    v_exp_f32 v52, v52
    v_exp_f32 v53, v53
    v_exp_f32 v54, v54
    v_exp_f32 v55, v55
    s_waitcnt lgkmcnt(0)
    v_cvt_pk_bf16_f32 v66, v52, v53
    v_cvt_pk_bf16_f32 v67, v54, v55
    v_mfma_f32_32x32x16_bf16 v[88:103], v[84:87], v[68:71], v[88:103]
    v_exp_f32 v56, v56
    v_exp_f32 v57, v57
    v_exp_f32 v58, v58
    v_exp_f32 v59, v59
    v_cvt_pk_bf16_f32 v68, v56, v57
    v_cvt_pk_bf16_f32 v69, v58, v59
    v_mfma_f32_32x32x16_bf16 v[104:119], v[80:83], v[64:67], v[104:119]
    ds_read_b128 v[80:83], v9 offset:14336
    v_exp_f32 v60, v60
    v_exp_f32 v61, v61
    v_exp_f32 v62, v62
    v_exp_f32 v63, v63
    s_setprio 3
    v_cvt_pk_bf16_f32 v70, v60, v61
    v_cvt_pk_bf16_f32 v71, v62, v63
    s_waitcnt vmcnt(0)
    s_barrier
    v_mfma_f32_32x32x16_bf16 v[48:63], v[72:75], v[24:27], 0
    ds_read_b128 v[72:75], v9 offset:32768
    v_exp_f32 v32, v32
    v_exp_f32 v33, v33
    v_exp_f32 v34, v34
    v_exp_f32 v35, v35
    v_cvt_pk_bf16_f32 v64, v32, v33
    v_cvt_pk_bf16_f32 v65, v34, v35
    v_mfma_f32_32x32x16_bf16 v[48:63], v[76:79], v[28:31], v[48:63]
    ds_read_b128 v[76:79], v9 offset:33792
    v_exp_f32 v36, v36
    v_exp_f32 v37, v37
    s_add_u32 s70, s6, 2
    s_and_b32 s70, s70, 7
    s_lshl_b32 s70, s70, 15
    s_add_u32 m0, s57, 65536
    s_add_u32 s65, s70, 0
    buffer_load_dwordx4 v3, s[36:39], s65 offen sc1 lds
    v_exp_f32 v38, v38
    v_exp_f32 v39, v39
    v_cvt_pk_bf16_f32 v66, v36, v37
    v_cvt_pk_bf16_f32 v67, v38, v39
    v_mfma_f32_32x32x16_bf16 v[104:119], v[84:87], v[68:71], v[104:119]
    ds_read_b128 v[84:87], v9 offset:15360
    v_exp_f32 v40, v40
    v_exp_f32 v41, v41
    v_exp_f32 v42, v42
    v_exp_f32 v43, v43
    s_waitcnt lgkmcnt(3)
    v_cvt_pk_bf16_f32 v68, v40, v41
    v_cvt_pk_bf16_f32 v69, v42, v43
    v_mfma_f32_32x32x16_bf16 v[88:103], v[80:83], v[64:67], v[88:103]
    v_exp_f32 v44, v44
    v_exp_f32 v45, v45
    v_exp_f32 v46, v46
    v_exp_f32 v47, v47
    s_waitcnt lgkmcnt(2)
    s_setprio 3
    v_cvt_pk_bf16_f32 v70, v44, v45
    v_cvt_pk_bf16_f32 v71, v46, v47
    v_mfma_f32_32x32x16_bf16 v[32:47], v[72:75], v[16:19], 0
    v_exp_f32 v48, v48
    v_exp_f32 v49, v49
    v_exp_f32 v50, v50
    v_exp_f32 v51, v51
    s_waitcnt lgkmcnt(1)
    v_cvt_pk_bf16_f32 v64, v48, v49
    v_cvt_pk_bf16_f32 v65, v50, v51
    v_mfma_f32_32x32x16_bf16 v[32:47], v[76:79], v[20:23], v[32:47]
    v_exp_f32 v52, v52
    v_exp_f32 v53, v53
    s_add_u32 m0, s57, 73728
    s_add_u32 s65, s70, 8192
    buffer_load_dwordx4 v3, s[36:39], s65 offen sc1 lds
    v_exp_f32 v54, v54
    v_exp_f32 v55, v55
    s_waitcnt lgkmcnt(0)
    v_cvt_pk_bf16_f32 v66, v52, v53
    v_cvt_pk_bf16_f32 v67, v54, v55
    v_mfma_f32_32x32x16_bf16 v[88:103], v[84:87], v[68:71], v[88:103]
    v_exp_f32 v56, v56
    v_exp_f32 v57, v57
    v_exp_f32 v58, v58
    v_exp_f32 v59, v59
    v_cvt_pk_bf16_f32 v68, v56, v57
    v_cvt_pk_bf16_f32 v69, v58, v59
    v_mfma_f32_32x32x16_bf16 v[104:119], v[80:83], v[64:67], v[104:119]
    ds_read_b128 v[80:83], v9 offset:34816
    v_exp_f32 v60, v60
    v_exp_f32 v61, v61
    v_exp_f32 v62, v62
    v_exp_f32 v63, v63
    s_setprio 2
    v_cvt_pk_bf16_f32 v70, v60, v61
    v_cvt_pk_bf16_f32 v71, v62, v63
    v_mfma_f32_32x32x16_bf16 v[48:63], v[72:75], v[24:27], 0
    ds_read_b128 v[72:75], v9 offset:36864
    v_exp_f32 v32, v32
    v_exp_f32 v33, v33
    v_exp_f32 v34, v34
    v_exp_f32 v35, v35
    v_cvt_pk_bf16_f32 v64, v32, v33
    v_cvt_pk_bf16_f32 v65, v34, v35
    v_mfma_f32_32x32x16_bf16 v[48:63], v[76:79], v[28:31], v[48:63]
    ds_read_b128 v[76:79], v9 offset:37888
    v_exp_f32 v36, v36
    v_exp_f32 v37, v37
    s_add_u32 m0, s57, 81920
    s_add_u32 s65, s70, 16384
    buffer_load_dwordx4 v3, s[36:39], s65 offen sc1 lds
    v_exp_f32 v38, v38
    v_exp_f32 v39, v39
    v_cvt_pk_bf16_f32 v66, v36, v37
    v_cvt_pk_bf16_f32 v67, v38, v39
    v_mfma_f32_32x32x16_bf16 v[104:119], v[84:87], v[68:71], v[104:119]
    ds_read_b128 v[84:87], v9 offset:35840
    v_exp_f32 v40, v40
    v_exp_f32 v41, v41
    v_exp_f32 v42, v42
    v_exp_f32 v43, v43
    s_waitcnt lgkmcnt(3)
    v_cvt_pk_bf16_f32 v68, v40, v41
    v_cvt_pk_bf16_f32 v69, v42, v43
    v_mfma_f32_32x32x16_bf16 v[88:103], v[80:83], v[64:67], v[88:103]
    v_exp_f32 v44, v44
    v_exp_f32 v45, v45
    v_exp_f32 v46, v46
    v_exp_f32 v47, v47
    s_waitcnt lgkmcnt(2)
    s_setprio 2
    v_cvt_pk_bf16_f32 v70, v44, v45
    v_cvt_pk_bf16_f32 v71, v46, v47
    v_mfma_f32_32x32x16_bf16 v[32:47], v[72:75], v[16:19], 0
    v_exp_f32 v48, v48
    v_exp_f32 v49, v49
    v_exp_f32 v50, v50
    v_exp_f32 v51, v51
    s_waitcnt lgkmcnt(1)
    v_cvt_pk_bf16_f32 v64, v48, v49
    v_cvt_pk_bf16_f32 v65, v50, v51
    v_mfma_f32_32x32x16_bf16 v[32:47], v[76:79], v[20:23], v[32:47]
    v_exp_f32 v52, v52
    v_exp_f32 v53, v53
    s_add_u32 m0, s57, 90112
    s_add_u32 s65, s70, 24576
    buffer_load_dwordx4 v3, s[36:39], s65 offen sc1 lds
    v_exp_f32 v54, v54
    v_exp_f32 v55, v55
    s_waitcnt lgkmcnt(0)
    v_cvt_pk_bf16_f32 v66, v52, v53
    v_cvt_pk_bf16_f32 v67, v54, v55
    v_mfma_f32_32x32x16_bf16 v[88:103], v[84:87], v[68:71], v[88:103]
    v_exp_f32 v56, v56
    v_exp_f32 v57, v57
    v_exp_f32 v58, v58
    v_exp_f32 v59, v59
    v_cvt_pk_bf16_f32 v68, v56, v57
    v_cvt_pk_bf16_f32 v69, v58, v59
    v_mfma_f32_32x32x16_bf16 v[104:119], v[80:83], v[64:67], v[104:119]
    ds_read_b128 v[80:83], v9 offset:38912
    v_exp_f32 v60, v60
    v_exp_f32 v61, v61
    v_exp_f32 v62, v62
    v_exp_f32 v63, v63
    s_setprio 1
    v_cvt_pk_bf16_f32 v70, v60, v61
    v_cvt_pk_bf16_f32 v71, v62, v63
    v_mfma_f32_32x32x16_bf16 v[48:63], v[72:75], v[24:27], 0
    ds_read_b128 v[72:75], v9 offset:40960
    v_exp_f32 v32, v32
    v_exp_f32 v33, v33
    v_exp_f32 v34, v34
    v_exp_f32 v35, v35
    v_cvt_pk_bf16_f32 v64, v32, v33
    v_cvt_pk_bf16_f32 v65, v34, v35
    v_mfma_f32_32x32x16_bf16 v[48:63], v[76:79], v[28:31], v[48:63]
    ds_read_b128 v[76:79], v9 offset:41984
    v_exp_f32 v36, v36
    v_exp_f32 v37, v37
    v_exp_f32 v38, v38
    v_exp_f32 v39, v39
    v_cvt_pk_bf16_f32 v66, v36, v37
    v_cvt_pk_bf16_f32 v67, v38, v39
    v_mfma_f32_32x32x16_bf16 v[104:119], v[84:87], v[68:71], v[104:119]
    ds_read_b128 v[84:87], v9 offset:39936
    v_exp_f32 v40, v40
    v_exp_f32 v41, v41
    v_exp_f32 v42, v42
    v_exp_f32 v43, v43
    s_waitcnt lgkmcnt(3)
    v_cvt_pk_bf16_f32 v68, v40, v41
    v_cvt_pk_bf16_f32 v69, v42, v43
    v_mfma_f32_32x32x16_bf16 v[88:103], v[80:83], v[64:67], v[88:103]
    v_exp_f32 v44, v44
    v_exp_f32 v45, v45
    v_exp_f32 v46, v46
    v_exp_f32 v47, v47
    s_waitcnt lgkmcnt(2)
    s_setprio 1
    v_cvt_pk_bf16_f32 v70, v44, v45
    v_cvt_pk_bf16_f32 v71, v46, v47
    v_mfma_f32_32x32x16_bf16 v[32:47], v[72:75], v[16:19], 0
    v_exp_f32 v48, v48
    v_exp_f32 v49, v49
    v_exp_f32 v50, v50
    v_exp_f32 v51, v51
    s_waitcnt lgkmcnt(1)
    v_cvt_pk_bf16_f32 v64, v48, v49
    v_cvt_pk_bf16_f32 v65, v50, v51
    v_mfma_f32_32x32x16_bf16 v[32:47], v[76:79], v[20:23], v[32:47]
    v_exp_f32 v52, v52
    v_exp_f32 v53, v53
    v_exp_f32 v54, v54
    v_exp_f32 v55, v55
    s_waitcnt lgkmcnt(0)
    v_cvt_pk_bf16_f32 v66, v52, v53
    v_cvt_pk_bf16_f32 v67, v54, v55
    v_mfma_f32_32x32x16_bf16 v[88:103], v[84:87], v[68:71], v[88:103]
    v_exp_f32 v56, v56
    v_exp_f32 v57, v57
    v_exp_f32 v58, v58
    v_exp_f32 v59, v59
    v_cvt_pk_bf16_f32 v68, v56, v57
    v_cvt_pk_bf16_f32 v69, v58, v59
    v_mfma_f32_32x32x16_bf16 v[104:119], v[80:83], v[64:67], v[104:119]
    ds_read_b128 v[80:83], v9 offset:43008
    v_exp_f32 v60, v60
    v_exp_f32 v61, v61
    v_exp_f32 v62, v62
    v_exp_f32 v63, v63
    s_setprio 0
    v_cvt_pk_bf16_f32 v70, v60, v61
    v_cvt_pk_bf16_f32 v71, v62, v63
    v_mfma_f32_32x32x16_bf16 v[48:63], v[72:75], v[24:27], 0
    ds_read_b128 v[72:75], v9 offset:45056
    v_exp_f32 v32, v32
    v_exp_f32 v33, v33
    v_exp_f32 v34, v34
    v_exp_f32 v35, v35
    v_cvt_pk_bf16_f32 v64, v32, v33
    v_cvt_pk_bf16_f32 v65, v34, v35
    v_mfma_f32_32x32x16_bf16 v[48:63], v[76:79], v[28:31], v[48:63]
    ds_read_b128 v[76:79], v9 offset:46080
    v_exp_f32 v36, v36
    v_exp_f32 v37, v37
    v_exp_f32 v38, v38
    v_exp_f32 v39, v39
    v_cvt_pk_bf16_f32 v66, v36, v37
    v_cvt_pk_bf16_f32 v67, v38, v39
    v_mfma_f32_32x32x16_bf16 v[104:119], v[84:87], v[68:71], v[104:119]
    ds_read_b128 v[84:87], v9 offset:44032
    v_exp_f32 v40, v40
    v_exp_f32 v41, v41
    v_exp_f32 v42, v42
    v_exp_f32 v43, v43
    s_waitcnt lgkmcnt(3)
    v_cvt_pk_bf16_f32 v68, v40, v41
    v_cvt_pk_bf16_f32 v69, v42, v43
    v_mfma_f32_32x32x16_bf16 v[88:103], v[80:83], v[64:67], v[88:103]
    v_exp_f32 v44, v44
    v_exp_f32 v45, v45
    v_exp_f32 v46, v46
    v_exp_f32 v47, v47
    s_waitcnt lgkmcnt(2)
    s_setprio 0
    v_cvt_pk_bf16_f32 v70, v44, v45
    v_cvt_pk_bf16_f32 v71, v46, v47
    v_mfma_f32_32x32x16_bf16 v[32:47], v[72:75], v[16:19], 0
    v_exp_f32 v48, v48
    v_exp_f32 v49, v49
    v_exp_f32 v50, v50
    v_exp_f32 v51, v51
    s_waitcnt lgkmcnt(1)
    v_cvt_pk_bf16_f32 v64, v48, v49
    v_cvt_pk_bf16_f32 v65, v50, v51
    v_mfma_f32_32x32x16_bf16 v[32:47], v[76:79], v[20:23], v[32:47]
    v_exp_f32 v52, v52
    v_exp_f32 v53, v53
    v_exp_f32 v54, v54
    v_exp_f32 v55, v55
    s_waitcnt lgkmcnt(0)
    v_cvt_pk_bf16_f32 v66, v52, v53
    v_cvt_pk_bf16_f32 v67, v54, v55
    v_mfma_f32_32x32x16_bf16 v[88:103], v[84:87], v[68:71], v[88:103]
    v_exp_f32 v56, v56
    v_exp_f32 v57, v57
    v_exp_f32 v58, v58
    v_exp_f32 v59, v59
    v_cvt_pk_bf16_f32 v68, v56, v57
    v_cvt_pk_bf16_f32 v69, v58, v59
    v_mfma_f32_32x32x16_bf16 v[104:119], v[80:83], v[64:67], v[104:119]
    ds_read_b128 v[80:83], v9 offset:47104
    v_exp_f32 v60, v60
    v_exp_f32 v61, v61
    v_exp_f32 v62, v62
    v_exp_f32 v63, v63
    s_setprio 3
    v_cvt_pk_bf16_f32 v70, v60, v61
    v_cvt_pk_bf16_f32 v71, v62, v63
    s_waitcnt vmcnt(0)
    s_barrier
    v_mfma_f32_32x32x16_bf16 v[48:63], v[72:75], v[24:27], 0
    ds_read_b128 v[72:75], v13 offset:0
    v_exp_f32 v32, v32
    v_exp_f32 v33, v33
    v_exp_f32 v34, v34
    v_exp_f32 v35, v35
    v_cvt_pk_bf16_f32 v64, v32, v33
    v_cvt_pk_bf16_f32 v65, v34, v35
    v_mfma_f32_32x32x16_bf16 v[48:63], v[76:79], v[28:31], v[48:63]
    ds_read_b128 v[76:79], v13 offset:1024
    v_exp_f32 v36, v36
    v_exp_f32 v37, v37
    s_add_u32 s70, s6, 3
    s_and_b32 s70, s70, 7
    s_lshl_b32 s70, s70, 15
    s_add_u32 m0, s57, 0
    s_add_u32 s65, s70, 0
    buffer_load_dwordx4 v3, s[36:39], s65 offen sc1 lds
    v_exp_f32 v38, v38
    v_exp_f32 v39, v39
    v_cvt_pk_bf16_f32 v66, v36, v37
    v_cvt_pk_bf16_f32 v67, v38, v39
    v_mfma_f32_32x32x16_bf16 v[104:119], v[84:87], v[68:71], v[104:119]
    ds_read_b128 v[84:87], v9 offset:48128
    v_exp_f32 v40, v40
    v_exp_f32 v41, v41
    v_exp_f32 v42, v42
    v_exp_f32 v43, v43
    s_waitcnt lgkmcnt(3)
    v_cvt_pk_bf16_f32 v68, v40, v41
    v_cvt_pk_bf16_f32 v69, v42, v43
    v_mfma_f32_32x32x16_bf16 v[88:103], v[80:83], v[64:67], v[88:103]
    v_exp_f32 v44, v44
    v_exp_f32 v45, v45
    v_exp_f32 v46, v46
    v_exp_f32 v47, v47
    s_waitcnt lgkmcnt(2)
    s_setprio 3
    v_cvt_pk_bf16_f32 v70, v44, v45
    v_cvt_pk_bf16_f32 v71, v46, v47
    v_mfma_f32_32x32x16_bf16 v[32:47], v[72:75], v[16:19], 0
    v_exp_f32 v48, v48
    v_exp_f32 v49, v49
    v_exp_f32 v50, v50
    v_exp_f32 v51, v51
    s_waitcnt lgkmcnt(1)
    v_cvt_pk_bf16_f32 v64, v48, v49
    v_cvt_pk_bf16_f32 v65, v50, v51
    v_mfma_f32_32x32x16_bf16 v[32:47], v[76:79], v[20:23], v[32:47]
    v_exp_f32 v52, v52
    v_exp_f32 v53, v53
    s_add_u32 m0, s57, 8192
    s_add_u32 s65, s70, 8192
    buffer_load_dwordx4 v3, s[36:39], s65 offen sc1 lds
    v_exp_f32 v54, v54
    v_exp_f32 v55, v55
    s_waitcnt lgkmcnt(0)
    v_cvt_pk_bf16_f32 v66, v52, v53
    v_cvt_pk_bf16_f32 v67, v54, v55
    v_mfma_f32_32x32x16_bf16 v[88:103], v[84:87], v[68:71], v[88:103]
    v_exp_f32 v56, v56
    v_exp_f32 v57, v57
    v_exp_f32 v58, v58
    v_exp_f32 v59, v59
    v_cvt_pk_bf16_f32 v68, v56, v57
    v_cvt_pk_bf16_f32 v69, v58, v59
    v_mfma_f32_32x32x16_bf16 v[104:119], v[80:83], v[64:67], v[104:119]
    ds_read_b128 v[80:83], v13 offset:2048
    v_exp_f32 v60, v60
    v_exp_f32 v61, v61
    v_exp_f32 v62, v62
    v_exp_f32 v63, v63
    s_setprio 2
    v_cvt_pk_bf16_f32 v70, v60, v61
    v_cvt_pk_bf16_f32 v71, v62, v63
    v_mfma_f32_32x32x16_bf16 v[48:63], v[72:75], v[24:27], 0
    ds_read_b128 v[72:75], v13 offset:4096
    v_exp_f32 v32, v32
    v_exp_f32 v33, v33
    v_exp_f32 v34, v34
    v_exp_f32 v35, v35
    v_cvt_pk_bf16_f32 v64, v32, v33
    v_cvt_pk_bf16_f32 v65, v34, v35
    v_mfma_f32_32x32x16_bf16 v[48:63], v[76:79], v[28:31], v[48:63]
    ds_read_b128 v[76:79], v13 offset:5120
    v_exp_f32 v36, v36
    v_exp_f32 v37, v37
    s_add_u32 m0, s57, 16384
    s_add_u32 s65, s70, 16384
    buffer_load_dwordx4 v3, s[36:39], s65 offen sc1 lds
    v_exp_f32 v38, v38
    v_exp_f32 v39, v39
    v_cvt_pk_bf16_f32 v66, v36, v37
    v_cvt_pk_bf16_f32 v67, v38, v39
    v_mfma_f32_32x32x16_bf16 v[104:119], v[84:87], v[68:71], v[104:119]
    ds_read_b128 v[84:87], v13 offset:3072
    v_exp_f32 v40, v40
    v_exp_f32 v41, v41
    v_exp_f32 v42, v42
    v_exp_f32 v43, v43
    s_waitcnt lgkmcnt(3)
    v_cvt_pk_bf16_f32 v68, v40, v41
    v_cvt_pk_bf16_f32 v69, v42, v43
    v_mfma_f32_32x32x16_bf16 v[88:103], v[80:83], v[64:67], v[88:103]
    v_exp_f32 v44, v44
    v_exp_f32 v45, v45
    v_exp_f32 v46, v46
    v_exp_f32 v47, v47
    s_waitcnt lgkmcnt(2)
    s_setprio 2
    v_cvt_pk_bf16_f32 v70, v44, v45
    v_cvt_pk_bf16_f32 v71, v46, v47
    v_mfma_f32_32x32x16_bf16 v[32:47], v[72:75], v[16:19], 0
    v_exp_f32 v48, v48
    v_exp_f32 v49, v49
    v_exp_f32 v50, v50
    v_exp_f32 v51, v51
    s_waitcnt lgkmcnt(1)
    v_cvt_pk_bf16_f32 v64, v48, v49
    v_cvt_pk_bf16_f32 v65, v50, v51
    v_mfma_f32_32x32x16_bf16 v[32:47], v[76:79], v[20:23], v[32:47]
    v_exp_f32 v52, v52
    v_exp_f32 v53, v53
    s_add_u32 m0, s57, 24576
    s_add_u32 s65, s70, 24576
    buffer_load_dwordx4 v3, s[36:39], s65 offen sc1 lds
    v_exp_f32 v54, v54
    v_exp_f32 v55, v55
    s_waitcnt lgkmcnt(0)
    v_cvt_pk_bf16_f32 v66, v52, v53
    v_cvt_pk_bf16_f32 v67, v54, v55
    v_mfma_f32_32x32x16_bf16 v[88:103], v[84:87], v[68:71], v[88:103]
    v_exp_f32 v56, v56
    v_exp_f32 v57, v57
    v_exp_f32 v58, v58
    v_exp_f32 v59, v59
    v_cvt_pk_bf16_f32 v68, v56, v57
    v_cvt_pk_bf16_f32 v69, v58, v59
    v_mfma_f32_32x32x16_bf16 v[104:119], v[80:83], v[64:67], v[104:119]
    ds_read_b128 v[80:83], v13 offset:6144
    v_exp_f32 v60, v60
    v_exp_f32 v61, v61
    v_exp_f32 v62, v62
    v_exp_f32 v63, v63
    s_setprio 1
    v_cvt_pk_bf16_f32 v70, v60, v61
    v_cvt_pk_bf16_f32 v71, v62, v63
    v_mfma_f32_32x32x16_bf16 v[48:63], v[72:75], v[24:27], 0
    ds_read_b128 v[72:75], v13 offset:8192
    v_exp_f32 v32, v32
    v_exp_f32 v33, v33
    v_exp_f32 v34, v34
    v_exp_f32 v35, v35
    v_cvt_pk_bf16_f32 v64, v32, v33
    v_cvt_pk_bf16_f32 v65, v34, v35
    v_mfma_f32_32x32x16_bf16 v[48:63], v[76:79], v[28:31], v[48:63]
    ds_read_b128 v[76:79], v13 offset:9216
    v_exp_f32 v36, v36
    v_exp_f32 v37, v37
    s_add_u32 s65, s9, 0
    s_cmp_ge_u32 s65, 29
    s_cselect_b32 s66, 29, 0
    s_cselect_b32 s67, 200704, 0
    s_cselect_b32 s60, 29696, 0
    s_sub_u32 s65, s65, s66
    s_lshl_b32 s66, s65, 10
    s_add_u32 s66, s66, s60
    s_add_u32 m0, s66, 98304
    s_mul_i32 s65, s65, 7168
    s_add_u32 s65, s65, s67
    s_add_u32 s65, s65, s56
    buffer_load_dwordx4 v15, s[40:43], s65 offen lds
    v_exp_f32 v38, v38
    v_exp_f32 v39, v39
    v_cvt_pk_bf16_f32 v66, v36, v37
    v_cvt_pk_bf16_f32 v67, v38, v39
    v_mfma_f32_32x32x16_bf16 v[104:119], v[84:87], v[68:71], v[104:119]
    ds_read_b128 v[84:87], v13 offset:7168
    v_exp_f32 v40, v40
    v_exp_f32 v41, v41
    v_exp_f32 v42, v42
    v_exp_f32 v43, v43
    s_waitcnt lgkmcnt(3)
    v_cvt_pk_bf16_f32 v68, v40, v41
    v_cvt_pk_bf16_f32 v69, v42, v43
    v_mfma_f32_32x32x16_bf16 v[88:103], v[80:83], v[64:67], v[88:103]
    v_exp_f32 v44, v44
    v_exp_f32 v45, v45
    v_exp_f32 v46, v46
    v_exp_f32 v47, v47
    s_waitcnt lgkmcnt(2)
    s_setprio 1
    v_cvt_pk_bf16_f32 v70, v44, v45
    v_cvt_pk_bf16_f32 v71, v46, v47
    v_mfma_f32_32x32x16_bf16 v[32:47], v[72:75], v[16:19], 0
    v_exp_f32 v48, v48
    v_exp_f32 v49, v49
    v_exp_f32 v50, v50
    v_exp_f32 v51, v51
    s_waitcnt lgkmcnt(1)
    v_cvt_pk_bf16_f32 v64, v48, v49
    v_cvt_pk_bf16_f32 v65, v50, v51
    v_mfma_f32_32x32x16_bf16 v[32:47], v[76:79], v[20:23], v[32:47]
    v_exp_f32 v52, v52
    v_exp_f32 v53, v53
    s_add_u32 s65, s9, 8
    s_cmp_ge_u32 s65, 29
    s_cselect_b32 s66, 29, 0
    s_cselect_b32 s67, 200704, 0
    s_cselect_b32 s60, 29696, 0
    s_sub_u32 s65, s65, s66
    s_lshl_b32 s66, s65, 10
    s_add_u32 s66, s66, s60
    s_add_u32 m0, s66, 98304
    s_mul_i32 s65, s65, 7168
    s_add_u32 s65, s65, s67
    s_add_u32 s65, s65, s56
    buffer_load_dwordx4 v15, s[40:43], s65 offen lds
    v_exp_f32 v54, v54
    v_exp_f32 v55, v55
    s_waitcnt lgkmcnt(0)
    v_cvt_pk_bf16_f32 v66, v52, v53
    v_cvt_pk_bf16_f32 v67, v54, v55
    v_mfma_f32_32x32x16_bf16 v[88:103], v[84:87], v[68:71], v[88:103]
    v_exp_f32 v56, v56
    v_exp_f32 v57, v57
    v_exp_f32 v58, v58
    v_exp_f32 v59, v59
    v_cvt_pk_bf16_f32 v68, v56, v57
    v_cvt_pk_bf16_f32 v69, v58, v59
    v_mfma_f32_32x32x16_bf16 v[104:119], v[80:83], v[64:67], v[104:119]
    ds_read_b128 v[80:83], v13 offset:10240
    v_exp_f32 v60, v60
    v_exp_f32 v61, v61
    v_exp_f32 v62, v62
    v_exp_f32 v63, v63
    s_setprio 0
    v_cvt_pk_bf16_f32 v70, v60, v61
    v_cvt_pk_bf16_f32 v71, v62, v63
    v_mfma_f32_32x32x16_bf16 v[48:63], v[72:75], v[24:27], 0
    ds_read_b128 v[72:75], v13 offset:12288
    v_exp_f32 v32, v32
    v_exp_f32 v33, v33
    v_exp_f32 v34, v34
    v_exp_f32 v35, v35
    v_cvt_pk_bf16_f32 v64, v32, v33
    v_cvt_pk_bf16_f32 v65, v34, v35
    v_mfma_f32_32x32x16_bf16 v[48:63], v[76:79], v[28:31], v[48:63]
    ds_read_b128 v[76:79], v13 offset:13312
    v_exp_f32 v36, v36
    v_exp_f32 v37, v37
    v_exp_f32 v38, v38
    v_exp_f32 v39, v39
    v_cvt_pk_bf16_f32 v66, v36, v37
    v_cvt_pk_bf16_f32 v67, v38, v39
    v_mfma_f32_32x32x16_bf16 v[104:119], v[84:87], v[68:71], v[104:119]
    ds_read_b128 v[84:87], v13 offset:11264
    v_exp_f32 v40, v40
    v_exp_f32 v41, v41
    v_exp_f32 v42, v42
    v_exp_f32 v43, v43
    s_waitcnt lgkmcnt(3)
    v_cvt_pk_bf16_f32 v68, v40, v41
    v_cvt_pk_bf16_f32 v69, v42, v43
    v_mfma_f32_32x32x16_bf16 v[88:103], v[80:83], v[64:67], v[88:103]
    v_exp_f32 v44, v44
    v_exp_f32 v45, v45
    v_exp_f32 v46, v46
    v_exp_f32 v47, v47
    s_waitcnt lgkmcnt(2)
    s_setprio 0
    v_cvt_pk_bf16_f32 v70, v44, v45
    v_cvt_pk_bf16_f32 v71, v46, v47
    v_mfma_f32_32x32x16_bf16 v[32:47], v[72:75], v[16:19], 0
    v_exp_f32 v48, v48
    v_exp_f32 v49, v49
    v_exp_f32 v50, v50
    v_exp_f32 v51, v51
    s_waitcnt lgkmcnt(1)
    v_cvt_pk_bf16_f32 v64, v48, v49
    v_cvt_pk_bf16_f32 v65, v50, v51
    v_mfma_f32_32x32x16_bf16 v[32:47], v[76:79], v[20:23], v[32:47]
    v_exp_f32 v52, v52
    v_exp_f32 v53, v53
    v_exp_f32 v54, v54
    v_exp_f32 v55, v55
    s_waitcnt lgkmcnt(0)
    v_cvt_pk_bf16_f32 v66, v52, v53
    v_cvt_pk_bf16_f32 v67, v54, v55
    v_mfma_f32_32x32x16_bf16 v[88:103], v[84:87], v[68:71], v[88:103]
    v_exp_f32 v56, v56
    v_exp_f32 v57, v57
    v_exp_f32 v58, v58
    v_exp_f32 v59, v59
    v_cvt_pk_bf16_f32 v68, v56, v57
    v_cvt_pk_bf16_f32 v69, v58, v59
    v_mfma_f32_32x32x16_bf16 v[104:119], v[80:83], v[64:67], v[104:119]
    ds_read_b128 v[80:83], v13 offset:14336
    v_exp_f32 v60, v60
    v_exp_f32 v61, v61
    v_exp_f32 v62, v62
    v_exp_f32 v63, v63
    s_setprio 3
    v_cvt_pk_bf16_f32 v70, v60, v61
    v_cvt_pk_bf16_f32 v71, v62, v63
    s_waitcnt vmcnt(0)
    s_barrier
    v_mfma_f32_32x32x16_bf16 v[48:63], v[72:75], v[24:27], 0
    ds_read_b128 v[72:75], v9 offset:0
    v_exp_f32 v32, v32
    v_exp_f32 v33, v33
    v_exp_f32 v34, v34
    v_exp_f32 v35, v35
    v_cvt_pk_bf16_f32 v64, v32, v33
    v_cvt_pk_bf16_f32 v65, v34, v35
    v_mfma_f32_32x32x16_bf16 v[48:63], v[76:79], v[28:31], v[48:63]
    ds_read_b128 v[76:79], v9 offset:1024
    v_exp_f32 v36, v36
    v_exp_f32 v37, v37
    s_add_u32 s70, s6, 4
    s_and_b32 s70, s70, 7
    s_lshl_b32 s70, s70, 15
    s_add_u32 m0, s57, 32768
    s_add_u32 s65, s70, 0
    buffer_load_dwordx4 v3, s[36:39], s65 offen sc1 lds
    v_exp_f32 v38, v38
    v_exp_f32 v39, v39
    v_cvt_pk_bf16_f32 v66, v36, v37
    v_cvt_pk_bf16_f32 v67, v38, v39
    v_mfma_f32_32x32x16_bf16 v[104:119], v[84:87], v[68:71], v[104:119]
    ds_read_b128 v[84:87], v13 offset:15360
    v_exp_f32 v40, v40
    v_exp_f32 v41, v41
    v_exp_f32 v42, v42
    v_exp_f32 v43, v43
    s_waitcnt lgkmcnt(3)
    v_cvt_pk_bf16_f32 v68, v40, v41
    v_cvt_pk_bf16_f32 v69, v42, v43
    v_mfma_f32_32x32x16_bf16 v[88:103], v[80:83], v[64:67], v[88:103]
    v_exp_f32 v44, v44
    v_exp_f32 v45, v45
    v_exp_f32 v46, v46
    v_exp_f32 v47, v47
    s_waitcnt lgkmcnt(2)
    s_setprio 3
    v_cvt_pk_bf16_f32 v70, v44, v45
    v_cvt_pk_bf16_f32 v71, v46, v47
    v_mfma_f32_32x32x16_bf16 v[32:47], v[72:75], v[16:19], 0
    v_exp_f32 v48, v48
    v_exp_f32 v49, v49
    v_exp_f32 v50, v50
    v_exp_f32 v51, v51
    s_waitcnt lgkmcnt(1)
    v_cvt_pk_bf16_f32 v64, v48, v49
    v_cvt_pk_bf16_f32 v65, v50, v51
    v_mfma_f32_32x32x16_bf16 v[32:47], v[76:79], v[20:23], v[32:47]
    v_exp_f32 v52, v52
    v_exp_f32 v53, v53
    s_add_u32 m0, s57, 40960
    s_add_u32 s65, s70, 8192
    buffer_load_dwordx4 v3, s[36:39], s65 offen sc1 lds
    v_exp_f32 v54, v54
    v_exp_f32 v55, v55
    s_waitcnt lgkmcnt(0)
    v_cvt_pk_bf16_f32 v66, v52, v53
    v_cvt_pk_bf16_f32 v67, v54, v55
    v_mfma_f32_32x32x16_bf16 v[88:103], v[84:87], v[68:71], v[88:103]
    v_exp_f32 v56, v56
    v_exp_f32 v57, v57
    v_exp_f32 v58, v58
    v_exp_f32 v59, v59
    v_cvt_pk_bf16_f32 v68, v56, v57
    v_cvt_pk_bf16_f32 v69, v58, v59
    v_mfma_f32_32x32x16_bf16 v[104:119], v[80:83], v[64:67], v[104:119]
    ds_read_b128 v[80:83], v9 offset:2048
    v_exp_f32 v60, v60
    v_exp_f32 v61, v61
    v_exp_f32 v62, v62
    v_exp_f32 v63, v63
    s_setprio 2
    v_cvt_pk_bf16_f32 v70, v60, v61
    v_cvt_pk_bf16_f32 v71, v62, v63
    v_mfma_f32_32x32x16_bf16 v[48:63], v[72:75], v[24:27], 0
    ds_read_b128 v[72:75], v9 offset:4096
    v_exp_f32 v32, v32
    v_exp_f32 v33, v33
    v_exp_f32 v34, v34
    v_exp_f32 v35, v35
    v_cvt_pk_bf16_f32 v64, v32, v33
    v_cvt_pk_bf16_f32 v65, v34, v35
    v_mfma_f32_32x32x16_bf16 v[48:63], v[76:79], v[28:31], v[48:63]
    ds_read_b128 v[76:79], v9 offset:5120
    v_exp_f32 v36, v36
    v_exp_f32 v37, v37
    s_add_u32 m0, s57, 49152
    s_add_u32 s65, s70, 16384
    buffer_load_dwordx4 v3, s[36:39], s65 offen sc1 lds
    v_exp_f32 v38, v38
    v_exp_f32 v39, v39
    v_cvt_pk_bf16_f32 v66, v36, v37
    v_cvt_pk_bf16_f32 v67, v38, v39
    v_mfma_f32_32x32x16_bf16 v[104:119], v[84:87], v[68:71], v[104:119]
    ds_read_b128 v[84:87], v9 offset:3072
    v_exp_f32 v40, v40
    v_exp_f32 v41, v41
    v_exp_f32 v42, v42
    v_exp_f32 v43, v43
    s_waitcnt lgkmcnt(3)
    v_cvt_pk_bf16_f32 v68, v40, v41
    v_cvt_pk_bf16_f32 v69, v42, v43
    v_mfma_f32_32x32x16_bf16 v[88:103], v[80:83], v[64:67], v[88:103]
    v_exp_f32 v44, v44
    v_exp_f32 v45, v45
    v_exp_f32 v46, v46
    v_exp_f32 v47, v47
    s_waitcnt lgkmcnt(2)
    s_setprio 2
    v_cvt_pk_bf16_f32 v70, v44, v45
    v_cvt_pk_bf16_f32 v71, v46, v47
    v_mfma_f32_32x32x16_bf16 v[32:47], v[72:75], v[16:19], 0
    v_exp_f32 v48, v48
    v_exp_f32 v49, v49
    v_exp_f32 v50, v50
    v_exp_f32 v51, v51
    s_waitcnt lgkmcnt(1)
    v_cvt_pk_bf16_f32 v64, v48, v49
    v_cvt_pk_bf16_f32 v65, v50, v51
    v_mfma_f32_32x32x16_bf16 v[32:47], v[76:79], v[20:23], v[32:47]
    v_exp_f32 v52, v52
    v_exp_f32 v53, v53
    s_add_u32 m0, s57, 57344
    s_add_u32 s65, s70, 24576
    buffer_load_dwordx4 v3, s[36:39], s65 offen sc1 lds
    v_exp_f32 v54, v54
    v_exp_f32 v55, v55
    s_waitcnt lgkmcnt(0)
    v_cvt_pk_bf16_f32 v66, v52, v53
    v_cvt_pk_bf16_f32 v67, v54, v55
    v_mfma_f32_32x32x16_bf16 v[88:103], v[84:87], v[68:71], v[88:103]
    v_exp_f32 v56, v56
    v_exp_f32 v57, v57
    v_exp_f32 v58, v58
    v_exp_f32 v59, v59
    v_cvt_pk_bf16_f32 v68, v56, v57
    v_cvt_pk_bf16_f32 v69, v58, v59
    v_mfma_f32_32x32x16_bf16 v[104:119], v[80:83], v[64:67], v[104:119]
    ds_read_b128 v[80:83], v9 offset:6144
    v_exp_f32 v60, v60
    v_exp_f32 v61, v61
    v_exp_f32 v62, v62
    v_exp_f32 v63, v63
    s_setprio 1
    v_cvt_pk_bf16_f32 v70, v60, v61
    v_cvt_pk_bf16_f32 v71, v62, v63
    v_mfma_f32_32x32x16_bf16 v[48:63], v[72:75], v[24:27], 0
    ds_read_b128 v[72:75], v9 offset:8192
    v_exp_f32 v32, v32
    v_exp_f32 v33, v33
    v_exp_f32 v34, v34
    v_exp_f32 v35, v35
    v_cvt_pk_bf16_f32 v64, v32, v33
    v_cvt_pk_bf16_f32 v65, v34, v35
    v_mfma_f32_32x32x16_bf16 v[48:63], v[76:79], v[28:31], v[48:63]
    ds_read_b128 v[76:79], v9 offset:9216
    v_exp_f32 v36, v36
    v_exp_f32 v37, v37
    s_add_u32 s65, s9, 16
    s_cmp_ge_u32 s65, 29
    s_cselect_b32 s66, 29, 0
    s_cselect_b32 s67, 200704, 0
    s_cselect_b32 s60, 29696, 0
    s_sub_u32 s65, s65, s66
    s_lshl_b32 s66, s65, 10
    s_add_u32 s66, s66, s60
    s_add_u32 m0, s66, 98304
    s_mul_i32 s65, s65, 7168
    s_add_u32 s65, s65, s67
    s_add_u32 s65, s65, s56
    buffer_load_dwordx4 v15, s[40:43], s65 offen lds
    v_exp_f32 v38, v38
    v_exp_f32 v39, v39
    v_cvt_pk_bf16_f32 v66, v36, v37
    v_cvt_pk_bf16_f32 v67, v38, v39
    v_mfma_f32_32x32x16_bf16 v[104:119], v[84:87], v[68:71], v[104:119]
    ds_read_b128 v[84:87], v9 offset:7168
    v_exp_f32 v40, v40
    v_exp_f32 v41, v41
    v_exp_f32 v42, v42
    v_exp_f32 v43, v43
    s_waitcnt lgkmcnt(3)
    v_cvt_pk_bf16_f32 v68, v40, v41
    v_cvt_pk_bf16_f32 v69, v42, v43
    v_mfma_f32_32x32x16_bf16 v[88:103], v[80:83], v[64:67], v[88:103]
    v_exp_f32 v44, v44
    v_exp_f32 v45, v45
    v_exp_f32 v46, v46
    v_exp_f32 v47, v47
    s_waitcnt lgkmcnt(2)
    s_setprio 1
    v_cvt_pk_bf16_f32 v70, v44, v45
    v_cvt_pk_bf16_f32 v71, v46, v47
    v_mfma_f32_32x32x16_bf16 v[32:47], v[72:75], v[16:19], 0
    v_exp_f32 v48, v48
    v_exp_f32 v49, v49
    v_exp_f32 v50, v50
    v_exp_f32 v51, v51
    s_waitcnt lgkmcnt(1)
    v_cvt_pk_bf16_f32 v64, v48, v49
    v_cvt_pk_bf16_f32 v65, v50, v51
    v_mfma_f32_32x32x16_bf16 v[32:47], v[76:79], v[20:23], v[32:47]
    v_exp_f32 v52, v52
    v_exp_f32 v53, v53
    s_add_u32 s65, s9, 24
    s_cmp_ge_u32 s65, 29
    s_cselect_b32 s66, 29, 0
    s_cselect_b32 s67, 200704, 0
    s_cselect_b32 s60, 29696, 0
    s_sub_u32 s65, s65, s66
    s_lshl_b32 s66, s65, 10
    s_add_u32 s66, s66, s60
    s_add_u32 m0, s66, 98304
    s_mul_i32 s65, s65, 7168
    s_add_u32 s65, s65, s67
    s_add_u32 s65, s65, s56
    buffer_load_dwordx4 v15, s[40:43], s65 offen lds
    v_exp_f32 v54, v54
    v_exp_f32 v55, v55
    s_waitcnt lgkmcnt(0)
    v_cvt_pk_bf16_f32 v66, v52, v53
    v_cvt_pk_bf16_f32 v67, v54, v55
    v_mfma_f32_32x32x16_bf16 v[88:103], v[84:87], v[68:71], v[88:103]
    v_exp_f32 v56, v56
    v_exp_f32 v57, v57
    v_exp_f32 v58, v58
    v_exp_f32 v59, v59
    v_cvt_pk_bf16_f32 v68, v56, v57
    v_cvt_pk_bf16_f32 v69, v58, v59
    v_mfma_f32_32x32x16_bf16 v[104:119], v[80:83], v[64:67], v[104:119]
    ds_read_b128 v[80:83], v9 offset:10240
    v_exp_f32 v60, v60
    v_exp_f32 v61, v61
    v_exp_f32 v62, v62
    v_exp_f32 v63, v63
    s_setprio 0
    v_cvt_pk_bf16_f32 v70, v60, v61
    v_cvt_pk_bf16_f32 v71, v62, v63
    v_mfma_f32_32x32x16_bf16 v[48:63], v[72:75], v[24:27], 0
    ds_read_b128 v[72:75], v9 offset:12288
    v_exp_f32 v32, v32
    v_exp_f32 v33, v33
    v_exp_f32 v34, v34
    v_exp_f32 v35, v35
    v_cvt_pk_bf16_f32 v64, v32, v33
    v_cvt_pk_bf16_f32 v65, v34, v35
    v_mfma_f32_32x32x16_bf16 v[48:63], v[76:79], v[28:31], v[48:63]
    ds_read_b128 v[76:79], v9 offset:13312
    v_exp_f32 v36, v36
    v_exp_f32 v37, v37
    v_exp_f32 v38, v38
    v_exp_f32 v39, v39
    v_cvt_pk_bf16_f32 v66, v36, v37
    v_cvt_pk_bf16_f32 v67, v38, v39
    v_mfma_f32_32x32x16_bf16 v[104:119], v[84:87], v[68:71], v[104:119]
    ds_read_b128 v[84:87], v9 offset:11264
    v_exp_f32 v40, v40
    v_exp_f32 v41, v41
    v_exp_f32 v42, v42
    v_exp_f32 v43, v43
    s_waitcnt lgkmcnt(3)
    v_cvt_pk_bf16_f32 v68, v40, v41
    v_cvt_pk_bf16_f32 v69, v42, v43
    v_mfma_f32_32x32x16_bf16 v[88:103], v[80:83], v[64:67], v[88:103]
    v_exp_f32 v44, v44
    v_exp_f32 v45, v45
    v_exp_f32 v46, v46
    v_exp_f32 v47, v47
    s_waitcnt lgkmcnt(2)
    s_setprio 0
    v_cvt_pk_bf16_f32 v70, v44, v45
    v_cvt_pk_bf16_f32 v71, v46, v47
    v_mfma_f32_32x32x16_bf16 v[32:47], v[72:75], v[16:19], 0
    v_exp_f32 v48, v48
    v_exp_f32 v49, v49
    v_exp_f32 v50, v50
    v_exp_f32 v51, v51
    s_waitcnt lgkmcnt(1)
    v_cvt_pk_bf16_f32 v64, v48, v49
    v_cvt_pk_bf16_f32 v65, v50, v51
    v_mfma_f32_32x32x16_bf16 v[32:47], v[76:79], v[20:23], v[32:47]
    v_exp_f32 v52, v52
    v_exp_f32 v53, v53
    v_exp_f32 v54, v54
    v_exp_f32 v55, v55
    s_waitcnt lgkmcnt(0)
    v_cvt_pk_bf16_f32 v66, v52, v53
    v_cvt_pk_bf16_f32 v67, v54, v55
    v_mfma_f32_32x32x16_bf16 v[88:103], v[84:87], v[68:71], v[88:103]
    v_exp_f32 v56, v56
    v_exp_f32 v57, v57
    v_exp_f32 v58, v58
    v_exp_f32 v59, v59
    v_cvt_pk_bf16_f32 v68, v56, v57
    v_cvt_pk_bf16_f32 v69, v58, v59
    v_mfma_f32_32x32x16_bf16 v[104:119], v[80:83], v[64:67], v[104:119]
    ds_read_b128 v[80:83], v9 offset:14336
    v_exp_f32 v60, v60
    v_exp_f32 v61, v61
    v_exp_f32 v62, v62
    v_exp_f32 v63, v63
    s_setprio 3
    v_cvt_pk_bf16_f32 v70, v60, v61
    v_cvt_pk_bf16_f32 v71, v62, v63
    s_waitcnt vmcnt(0)
    s_barrier
    v_mfma_f32_32x32x16_bf16 v[48:63], v[72:75], v[24:27], 0
    ds_read_b128 v[72:75], v9 offset:32768
    v_exp_f32 v32, v32
    v_exp_f32 v33, v33
    v_exp_f32 v34, v34
    v_exp_f32 v35, v35
    v_cvt_pk_bf16_f32 v64, v32, v33
    v_cvt_pk_bf16_f32 v65, v34, v35
    v_mfma_f32_32x32x16_bf16 v[48:63], v[76:79], v[28:31], v[48:63]
    ds_read_b128 v[76:79], v9 offset:33792
    v_exp_f32 v36, v36
    v_exp_f32 v37, v37
    s_add_u32 s70, s6, 5
    s_and_b32 s70, s70, 7
    s_lshl_b32 s70, s70, 15
    s_add_u32 m0, s57, 65536
    s_add_u32 s65, s70, 0
    buffer_load_dwordx4 v3, s[36:39], s65 offen sc1 lds
    v_exp_f32 v38, v38
    v_exp_f32 v39, v39
    v_cvt_pk_bf16_f32 v66, v36, v37
    v_cvt_pk_bf16_f32 v67, v38, v39
    v_mfma_f32_32x32x16_bf16 v[104:119], v[84:87], v[68:71], v[104:119]
    ds_read_b128 v[84:87], v9 offset:15360
    v_exp_f32 v40, v40
    v_exp_f32 v41, v41
    v_exp_f32 v42, v42
    v_exp_f32 v43, v43
    s_waitcnt lgkmcnt(3)
    v_cvt_pk_bf16_f32 v68, v40, v41
    v_cvt_pk_bf16_f32 v69, v42, v43
    v_mfma_f32_32x32x16_bf16 v[88:103], v[80:83], v[64:67], v[88:103]
    v_exp_f32 v44, v44
    v_exp_f32 v45, v45
    v_exp_f32 v46, v46
    v_exp_f32 v47, v47
    s_waitcnt lgkmcnt(2)
    s_setprio 3
    v_cvt_pk_bf16_f32 v70, v44, v45
    v_cvt_pk_bf16_f32 v71, v46, v47
    v_mfma_f32_32x32x16_bf16 v[32:47], v[72:75], v[16:19], 0
    v_exp_f32 v48, v48
    v_exp_f32 v49, v49
    v_exp_f32 v50, v50
    v_exp_f32 v51, v51
    s_waitcnt lgkmcnt(1)
    v_cvt_pk_bf16_f32 v64, v48, v49
    v_cvt_pk_bf16_f32 v65, v50, v51
    v_mfma_f32_32x32x16_bf16 v[32:47], v[76:79], v[20:23], v[32:47]
    v_exp_f32 v52, v52
    v_exp_f32 v53, v53
    s_add_u32 m0, s57, 73728
    s_add_u32 s65, s70, 8192
    buffer_load_dwordx4 v3, s[36:39], s65 offen sc1 lds
    v_exp_f32 v54, v54
    v_exp_f32 v55, v55
    s_waitcnt lgkmcnt(0)
    v_cvt_pk_bf16_f32 v66, v52, v53
    v_cvt_pk_bf16_f32 v67, v54, v55
    v_mfma_f32_32x32x16_bf16 v[88:103], v[84:87], v[68:71], v[88:103]
    v_exp_f32 v56, v56
    v_exp_f32 v57, v57
    v_exp_f32 v58, v58
    v_exp_f32 v59, v59
    v_cvt_pk_bf16_f32 v68, v56, v57
    v_cvt_pk_bf16_f32 v69, v58, v59
    v_mfma_f32_32x32x16_bf16 v[104:119], v[80:83], v[64:67], v[104:119]
    ds_read_b128 v[80:83], v9 offset:34816
    v_exp_f32 v60, v60
    v_exp_f32 v61, v61
    v_exp_f32 v62, v62
    v_exp_f32 v63, v63
    s_setprio 2
    v_cvt_pk_bf16_f32 v70, v60, v61
    v_cvt_pk_bf16_f32 v71, v62, v63
    v_mfma_f32_32x32x16_bf16 v[48:63], v[72:75], v[24:27], 0
    ds_read_b128 v[72:75], v9 offset:36864
    v_exp_f32 v32, v32
    v_exp_f32 v33, v33
    v_exp_f32 v34, v34
    v_exp_f32 v35, v35
    v_cvt_pk_bf16_f32 v64, v32, v33
    v_cvt_pk_bf16_f32 v65, v34, v35
    v_mfma_f32_32x32x16_bf16 v[48:63], v[76:79], v[28:31], v[48:63]
    ds_read_b128 v[76:79], v9 offset:37888
    v_exp_f32 v36, v36
    v_exp_f32 v37, v37
    s_add_u32 m0, s57, 81920
    s_add_u32 s65, s70, 16384
    buffer_load_dwordx4 v3, s[36:39], s65 offen sc1 lds
    v_exp_f32 v38, v38
    v_exp_f32 v39, v39
    v_cvt_pk_bf16_f32 v66, v36, v37
    v_cvt_pk_bf16_f32 v67, v38, v39
    v_mfma_f32_32x32x16_bf16 v[104:119], v[84:87], v[68:71], v[104:119]
    ds_read_b128 v[84:87], v9 offset:35840
    v_exp_f32 v40, v40
    v_exp_f32 v41, v41
    v_exp_f32 v42, v42
    v_exp_f32 v43, v43
    s_waitcnt lgkmcnt(3)
    v_cvt_pk_bf16_f32 v68, v40, v41
    v_cvt_pk_bf16_f32 v69, v42, v43
    v_mfma_f32_32x32x16_bf16 v[88:103], v[80:83], v[64:67], v[88:103]
    v_exp_f32 v44, v44
    v_exp_f32 v45, v45
    v_exp_f32 v46, v46
    v_exp_f32 v47, v47
    s_waitcnt lgkmcnt(2)
    s_setprio 2
    v_cvt_pk_bf16_f32 v70, v44, v45
    v_cvt_pk_bf16_f32 v71, v46, v47
    v_mfma_f32_32x32x16_bf16 v[32:47], v[72:75], v[16:19], 0
    v_exp_f32 v48, v48
    v_exp_f32 v49, v49
    v_exp_f32 v50, v50
    v_exp_f32 v51, v51
    s_waitcnt lgkmcnt(1)
    v_cvt_pk_bf16_f32 v64, v48, v49
    v_cvt_pk_bf16_f32 v65, v50, v51
    v_mfma_f32_32x32x16_bf16 v[32:47], v[76:79], v[20:23], v[32:47]
    v_exp_f32 v52, v52
    v_exp_f32 v53, v53
    s_add_u32 m0, s57, 90112
    s_add_u32 s65, s70, 24576
    buffer_load_dwordx4 v3, s[36:39], s65 offen sc1 lds
    v_exp_f32 v54, v54
    v_exp_f32 v55, v55
    s_waitcnt lgkmcnt(0)
    v_cvt_pk_bf16_f32 v66, v52, v53
    v_cvt_pk_bf16_f32 v67, v54, v55
    v_mfma_f32_32x32x16_bf16 v[88:103], v[84:87], v[68:71], v[88:103]
    v_exp_f32 v56, v56
    v_exp_f32 v57, v57
    v_exp_f32 v58, v58
    v_exp_f32 v59, v59
    v_cvt_pk_bf16_f32 v68, v56, v57
    v_cvt_pk_bf16_f32 v69, v58, v59
    v_mfma_f32_32x32x16_bf16 v[104:119], v[80:83], v[64:67], v[104:119]
    ds_read_b128 v[80:83], v9 offset:38912
    v_exp_f32 v60, v60
    v_exp_f32 v61, v61
    v_exp_f32 v62, v62
    v_exp_f32 v63, v63
    s_setprio 1
    v_cvt_pk_bf16_f32 v70, v60, v61
    v_cvt_pk_bf16_f32 v71, v62, v63
    v_mfma_f32_32x32x16_bf16 v[48:63], v[72:75], v[24:27], 0
    ds_read_b128 v[72:75], v9 offset:40960
    v_exp_f32 v32, v32
    v_exp_f32 v33, v33
    v_exp_f32 v34, v34
    v_exp_f32 v35, v35
    v_cvt_pk_bf16_f32 v64, v32, v33
    v_cvt_pk_bf16_f32 v65, v34, v35
    v_mfma_f32_32x32x16_bf16 v[48:63], v[76:79], v[28:31], v[48:63]
    ds_read_b128 v[76:79], v9 offset:41984
    v_exp_f32 v36, v36
    v_exp_f32 v37, v37
    s_add_u32 s65, s9, 32
    s_cmp_ge_u32 s65, 29
    s_cselect_b32 s66, 29, 0
    s_cselect_b32 s67, 200704, 0
    s_cselect_b32 s60, 29696, 0
    s_sub_u32 s65, s65, s66
    s_lshl_b32 s66, s65, 10
    s_add_u32 s66, s66, s60
    s_add_u32 m0, s66, 98304
    s_mul_i32 s65, s65, 7168
    s_add_u32 s65, s65, s67
    s_add_u32 s65, s65, s56
    buffer_load_dwordx4 v15, s[40:43], s65 offen lds
    v_exp_f32 v38, v38
    v_exp_f32 v39, v39
    v_cvt_pk_bf16_f32 v66, v36, v37
    v_cvt_pk_bf16_f32 v67, v38, v39
    v_mfma_f32_32x32x16_bf16 v[104:119], v[84:87], v[68:71], v[104:119]
    ds_read_b128 v[84:87], v9 offset:39936
    v_exp_f32 v40, v40
    v_exp_f32 v41, v41
    v_exp_f32 v42, v42
    v_exp_f32 v43, v43
    s_waitcnt lgkmcnt(3)
    v_cvt_pk_bf16_f32 v68, v40, v41
    v_cvt_pk_bf16_f32 v69, v42, v43
    v_mfma_f32_32x32x16_bf16 v[88:103], v[80:83], v[64:67], v[88:103]
    v_exp_f32 v44, v44
    v_exp_f32 v45, v45
    v_exp_f32 v46, v46
    v_exp_f32 v47, v47
    s_waitcnt lgkmcnt(2)
    s_setprio 1
    v_cvt_pk_bf16_f32 v70, v44, v45
    v_cvt_pk_bf16_f32 v71, v46, v47
    v_mfma_f32_32x32x16_bf16 v[32:47], v[72:75], v[16:19], 0
    v_exp_f32 v48, v48
    v_exp_f32 v49, v49
    v_exp_f32 v50, v50
    v_exp_f32 v51, v51
    s_waitcnt lgkmcnt(1)
    v_cvt_pk_bf16_f32 v64, v48, v49
    v_cvt_pk_bf16_f32 v65, v50, v51
    v_mfma_f32_32x32x16_bf16 v[32:47], v[76:79], v[20:23], v[32:47]
    v_exp_f32 v52, v52
    v_exp_f32 v53, v53
    s_add_u32 s65, s9, 40
    s_cmp_ge_u32 s65, 29
    s_cselect_b32 s66, 29, 0
    s_cselect_b32 s67, 200704, 0
    s_cselect_b32 s60, 29696, 0
    s_sub_u32 s65, s65, s66
    s_lshl_b32 s66, s65, 10
    s_add_u32 s66, s66, s60
    s_add_u32 m0, s66, 98304
    s_mul_i32 s65, s65, 7168
    s_add_u32 s65, s65, s67
    s_add_u32 s65, s65, s56
    buffer_load_dwordx4 v15, s[40:43], s65 offen lds
    v_exp_f32 v54, v54
    v_exp_f32 v55, v55
    s_waitcnt lgkmcnt(0)
    v_cvt_pk_bf16_f32 v66, v52, v53
    v_cvt_pk_bf16_f32 v67, v54, v55
    v_mfma_f32_32x32x16_bf16 v[88:103], v[84:87], v[68:71], v[88:103]
    v_exp_f32 v56, v56
    v_exp_f32 v57, v57
    v_exp_f32 v58, v58
    v_exp_f32 v59, v59
    v_cvt_pk_bf16_f32 v68, v56, v57
    v_cvt_pk_bf16_f32 v69, v58, v59
    v_mfma_f32_32x32x16_bf16 v[104:119], v[80:83], v[64:67], v[104:119]
    ds_read_b128 v[80:83], v9 offset:43008
    v_exp_f32 v60, v60
    v_exp_f32 v61, v61
    v_exp_f32 v62, v62
    v_exp_f32 v63, v63
    s_setprio 0
    v_cvt_pk_bf16_f32 v70, v60, v61
    v_cvt_pk_bf16_f32 v71, v62, v63
    v_mfma_f32_32x32x16_bf16 v[48:63], v[72:75], v[24:27], 0
    ds_read_b128 v[72:75], v9 offset:45056
    v_exp_f32 v32, v32
    v_exp_f32 v33, v33
    v_exp_f32 v34, v34
    v_exp_f32 v35, v35
    v_cvt_pk_bf16_f32 v64, v32, v33
    v_cvt_pk_bf16_f32 v65, v34, v35
    v_mfma_f32_32x32x16_bf16 v[48:63], v[76:79], v[28:31], v[48:63]
    ds_read_b128 v[76:79], v9 offset:46080
    v_exp_f32 v36, v36
    v_exp_f32 v37, v37
    v_exp_f32 v38, v38
    v_exp_f32 v39, v39
    v_cvt_pk_bf16_f32 v66, v36, v37
    v_cvt_pk_bf16_f32 v67, v38, v39
    v_mfma_f32_32x32x16_bf16 v[104:119], v[84:87], v[68:71], v[104:119]
    ds_read_b128 v[84:87], v9 offset:44032
    v_exp_f32 v40, v40
    v_exp_f32 v41, v41
    v_exp_f32 v42, v42
    v_exp_f32 v43, v43
    s_waitcnt lgkmcnt(3)
    v_cvt_pk_bf16_f32 v68, v40, v41
    v_cvt_pk_bf16_f32 v69, v42, v43
    v_mfma_f32_32x32x16_bf16 v[88:103], v[80:83], v[64:67], v[88:103]
    v_exp_f32 v44, v44
    v_exp_f32 v45, v45
    v_exp_f32 v46, v46
    v_exp_f32 v47, v47
    s_waitcnt lgkmcnt(2)
    s_setprio 0
    v_cvt_pk_bf16_f32 v70, v44, v45
    v_cvt_pk_bf16_f32 v71, v46, v47
    v_mfma_f32_32x32x16_bf16 v[32:47], v[72:75], v[16:19], 0
    v_exp_f32 v48, v48
    v_exp_f32 v49, v49
    v_exp_f32 v50, v50
    v_exp_f32 v51, v51
    s_waitcnt lgkmcnt(1)
    v_cvt_pk_bf16_f32 v64, v48, v49
    v_cvt_pk_bf16_f32 v65, v50, v51
    v_mfma_f32_32x32x16_bf16 v[32:47], v[76:79], v[20:23], v[32:47]
    v_exp_f32 v52, v52
    v_exp_f32 v53, v53
    v_exp_f32 v54, v54
    v_exp_f32 v55, v55
    s_waitcnt lgkmcnt(0)
    v_cvt_pk_bf16_f32 v66, v52, v53
    v_cvt_pk_bf16_f32 v67, v54, v55
    v_mfma_f32_32x32x16_bf16 v[88:103], v[84:87], v[68:71], v[88:103]
    v_exp_f32 v56, v56
    v_exp_f32 v57, v57
    v_exp_f32 v58, v58
    v_exp_f32 v59, v59
    v_cvt_pk_bf16_f32 v68, v56, v57
    v_cvt_pk_bf16_f32 v69, v58, v59
    v_mfma_f32_32x32x16_bf16 v[104:119], v[80:83], v[64:67], v[104:119]
    ds_read_b128 v[80:83], v9 offset:47104
    v_exp_f32 v60, v60
    v_exp_f32 v61, v61
    v_exp_f32 v62, v62
    v_exp_f32 v63, v63
    s_setprio 3
    v_cvt_pk_bf16_f32 v70, v60, v61
    v_cvt_pk_bf16_f32 v71, v62, v63
    s_waitcnt vmcnt(0)
    s_barrier
    v_mfma_f32_32x32x16_bf16 v[48:63], v[72:75], v[24:27], 0
    ds_read_b128 v[72:75], v13 offset:0
    v_exp_f32 v32, v32
    v_exp_f32 v33, v33
    v_exp_f32 v34, v34
    v_exp_f32 v35, v35
    v_cvt_pk_bf16_f32 v64, v32, v33
    v_cvt_pk_bf16_f32 v65, v34, v35
    v_mfma_f32_32x32x16_bf16 v[48:63], v[76:79], v[28:31], v[48:63]
    ds_read_b128 v[76:79], v13 offset:1024
    v_exp_f32 v36, v36
    v_exp_f32 v37, v37
    s_add_u32 s70, s6, 6
    s_and_b32 s70, s70, 7
    s_lshl_b32 s70, s70, 15
    s_add_u32 m0, s57, 0
    s_add_u32 s65, s70, 0
    buffer_load_dwordx4 v3, s[36:39], s65 offen sc1 lds
    v_exp_f32 v38, v38
    v_exp_f32 v39, v39
    v_cvt_pk_bf16_f32 v66, v36, v37
    v_cvt_pk_bf16_f32 v67, v38, v39
    v_mfma_f32_32x32x16_bf16 v[104:119], v[84:87], v[68:71], v[104:119]
    ds_read_b128 v[84:87], v9 offset:48128
    v_exp_f32 v40, v40
    v_exp_f32 v41, v41
    v_exp_f32 v42, v42
    v_exp_f32 v43, v43
    s_waitcnt lgkmcnt(3)
    v_cvt_pk_bf16_f32 v68, v40, v41
    v_cvt_pk_bf16_f32 v69, v42, v43
    v_mfma_f32_32x32x16_bf16 v[88:103], v[80:83], v[64:67], v[88:103]
    v_exp_f32 v44, v44
    v_exp_f32 v45, v45
    v_exp_f32 v46, v46
    v_exp_f32 v47, v47
    s_waitcnt lgkmcnt(2)
    s_setprio 3
    v_cvt_pk_bf16_f32 v70, v44, v45
    v_cvt_pk_bf16_f32 v71, v46, v47
    v_mfma_f32_32x32x16_bf16 v[32:47], v[72:75], v[16:19], 0
    v_exp_f32 v48, v48
    v_exp_f32 v49, v49
    v_exp_f32 v50, v50
    v_exp_f32 v51, v51
    s_waitcnt lgkmcnt(1)
    v_cvt_pk_bf16_f32 v64, v48, v49
    v_cvt_pk_bf16_f32 v65, v50, v51
    v_mfma_f32_32x32x16_bf16 v[32:47], v[76:79], v[20:23], v[32:47]
    v_exp_f32 v52, v52
    v_exp_f32 v53, v53
    s_add_u32 m0, s57, 8192
    s_add_u32 s65, s70, 8192
    buffer_load_dwordx4 v3, s[36:39], s65 offen sc1 lds
    v_exp_f32 v54, v54
    v_exp_f32 v55, v55
    s_waitcnt lgkmcnt(0)
    v_cvt_pk_bf16_f32 v66, v52, v53
    v_cvt_pk_bf16_f32 v67, v54, v55
    v_mfma_f32_32x32x16_bf16 v[88:103], v[84:87], v[68:71], v[88:103]
    v_exp_f32 v56, v56
    v_exp_f32 v57, v57
    v_exp_f32 v58, v58
    v_exp_f32 v59, v59
    v_cvt_pk_bf16_f32 v68, v56, v57
    v_cvt_pk_bf16_f32 v69, v58, v59
    v_mfma_f32_32x32x16_bf16 v[104:119], v[80:83], v[64:67], v[104:119]
    ds_read_b128 v[80:83], v13 offset:2048
    v_exp_f32 v60, v60
    v_exp_f32 v61, v61
    v_exp_f32 v62, v62
    v_exp_f32 v63, v63
    s_setprio 2
    v_cvt_pk_bf16_f32 v70, v60, v61
    v_cvt_pk_bf16_f32 v71, v62, v63
    v_mfma_f32_32x32x16_bf16 v[48:63], v[72:75], v[24:27], 0
    ds_read_b128 v[72:75], v13 offset:4096
    v_exp_f32 v32, v32
    v_exp_f32 v33, v33
    v_exp_f32 v34, v34
    v_exp_f32 v35, v35
    v_cvt_pk_bf16_f32 v64, v32, v33
    v_cvt_pk_bf16_f32 v65, v34, v35
    v_mfma_f32_32x32x16_bf16 v[48:63], v[76:79], v[28:31], v[48:63]
    ds_read_b128 v[76:79], v13 offset:5120
    v_exp_f32 v36, v36
    v_exp_f32 v37, v37
    s_add_u32 m0, s57, 16384
    s_add_u32 s65, s70, 16384
    buffer_load_dwordx4 v3, s[36:39], s65 offen sc1 lds
    v_exp_f32 v38, v38
    v_exp_f32 v39, v39
    v_cvt_pk_bf16_f32 v66, v36, v37
    v_cvt_pk_bf16_f32 v67, v38, v39
    v_mfma_f32_32x32x16_bf16 v[104:119], v[84:87], v[68:71], v[104:119]
    ds_read_b128 v[84:87], v13 offset:3072
    v_exp_f32 v40, v40
    v_exp_f32 v41, v41
    v_exp_f32 v42, v42
    v_exp_f32 v43, v43
    s_waitcnt lgkmcnt(3)
    v_cvt_pk_bf16_f32 v68, v40, v41
    v_cvt_pk_bf16_f32 v69, v42, v43
    v_mfma_f32_32x32x16_bf16 v[88:103], v[80:83], v[64:67], v[88:103]
    v_exp_f32 v44, v44
    v_exp_f32 v45, v45
    v_exp_f32 v46, v46
    v_exp_f32 v47, v47
    s_waitcnt lgkmcnt(2)
    s_setprio 2
    v_cvt_pk_bf16_f32 v70, v44, v45
    v_cvt_pk_bf16_f32 v71, v46, v47
    v_mfma_f32_32x32x16_bf16 v[32:47], v[72:75], v[16:19], 0
    v_exp_f32 v48, v48
    v_exp_f32 v49, v49
    v_exp_f32 v50, v50
    v_exp_f32 v51, v51
    s_waitcnt lgkmcnt(1)
    v_cvt_pk_bf16_f32 v64, v48, v49
    v_cvt_pk_bf16_f32 v65, v50, v51
    v_mfma_f32_32x32x16_bf16 v[32:47], v[76:79], v[20:23], v[32:47]
    v_exp_f32 v52, v52
    v_exp_f32 v53, v53
    s_add_u32 m0, s57, 24576
    s_add_u32 s65, s70, 24576
    buffer_load_dwordx4 v3, s[36:39], s65 offen sc1 lds
    v_exp_f32 v54, v54
    v_exp_f32 v55, v55
    s_waitcnt lgkmcnt(0)
    v_cvt_pk_bf16_f32 v66, v52, v53
    v_cvt_pk_bf16_f32 v67, v54, v55
    v_mfma_f32_32x32x16_bf16 v[88:103], v[84:87], v[68:71], v[88:103]
    v_exp_f32 v56, v56
    v_exp_f32 v57, v57
    v_exp_f32 v58, v58
    v_exp_f32 v59, v59
    v_cvt_pk_bf16_f32 v68, v56, v57
    v_cvt_pk_bf16_f32 v69, v58, v59
    v_mfma_f32_32x32x16_bf16 v[104:119], v[80:83], v[64:67], v[104:119]
    ds_read_b128 v[80:83], v13 offset:6144
    v_exp_f32 v60, v60
    v_exp_f32 v61, v61
    v_exp_f32 v62, v62
    v_exp_f32 v63, v63
    s_setprio 1
    v_cvt_pk_bf16_f32 v70, v60, v61
    v_cvt_pk_bf16_f32 v71, v62, v63
    v_mfma_f32_32x32x16_bf16 v[48:63], v[72:75], v[24:27], 0
    ds_read_b128 v[72:75], v13 offset:8192
    v_exp_f32 v32, v32
    v_exp_f32 v33, v33
    v_exp_f32 v34, v34
    v_exp_f32 v35, v35
    v_cvt_pk_bf16_f32 v64, v32, v33
    v_cvt_pk_bf16_f32 v65, v34, v35
    v_mfma_f32_32x32x16_bf16 v[48:63], v[76:79], v[28:31], v[48:63]
    ds_read_b128 v[76:79], v13 offset:9216
    v_exp_f32 v36, v36
    v_exp_f32 v37, v37
    s_add_u32 s65, s9, 48
    s_cmp_ge_u32 s65, 29
    s_cselect_b32 s66, 29, 0
    s_cselect_b32 s67, 200704, 0
    s_cselect_b32 s60, 29696, 0
    s_sub_u32 s65, s65, s66
    s_lshl_b32 s66, s65, 10
    s_add_u32 s66, s66, s60
    s_add_u32 m0, s66, 98304
    s_mul_i32 s65, s65, 7168
    s_add_u32 s65, s65, s67
    s_add_u32 s65, s65, s56
    buffer_load_dwordx4 v15, s[40:43], s65 offen lds
    v_exp_f32 v38, v38
    v_exp_f32 v39, v39
    v_cvt_pk_bf16_f32 v66, v36, v37
    v_cvt_pk_bf16_f32 v67, v38, v39
    v_mfma_f32_32x32x16_bf16 v[104:119], v[84:87], v[68:71], v[104:119]
    ds_read_b128 v[84:87], v13 offset:7168
    v_exp_f32 v40, v40
    v_exp_f32 v41, v41
    v_exp_f32 v42, v42
    v_exp_f32 v43, v43
    s_waitcnt lgkmcnt(3)
    v_cvt_pk_bf16_f32 v68, v40, v41
    v_cvt_pk_bf16_f32 v69, v42, v43
    v_mfma_f32_32x32x16_bf16 v[88:103], v[80:83], v[64:67], v[88:103]
    v_exp_f32 v44, v44
    v_exp_f32 v45, v45
    v_exp_f32 v46, v46
    v_exp_f32 v47, v47
    s_waitcnt lgkmcnt(2)
    s_setprio 1
    v_cvt_pk_bf16_f32 v70, v44, v45
    v_cvt_pk_bf16_f32 v71, v46, v47
    v_mfma_f32_32x32x16_bf16 v[32:47], v[72:75], v[16:19], 0
    v_exp_f32 v48, v48
    v_exp_f32 v49, v49
    v_exp_f32 v50, v50
    v_exp_f32 v51, v51
    s_waitcnt lgkmcnt(1)
    v_cvt_pk_bf16_f32 v64, v48, v49
    v_cvt_pk_bf16_f32 v65, v50, v51
    v_mfma_f32_32x32x16_bf16 v[32:47], v[76:79], v[20:23], v[32:47]
    v_exp_f32 v52, v52
    v_exp_f32 v53, v53
    s_add_u32 s65, s9, 56
    s_cmp_ge_u32 s65, 58
    s_cselect_b32 s66, 58, 0
    s_sub_u32 s65, s65, s66
    s_cmp_ge_u32 s65, 29
    s_cselect_b32 s66, 29, 0
    s_cselect_b32 s67, 200704, 0
    s_cselect_b32 s60, 29696, 0
    s_sub_u32 s65, s65, s66
    s_lshl_b32 s66, s65, 10
    s_add_u32 s66, s66, s60
    s_add_u32 m0, s66, 98304
    s_mul_i32 s65, s65, 7168
    s_add_u32 s65, s65, s67
    s_add_u32 s65, s65, s56
    buffer_load_dwordx4 v15, s[40:43], s65 offen lds
    v_exp_f32 v54, v54
    v_exp_f32 v55, v55
    s_waitcnt lgkmcnt(0)
    v_cvt_pk_bf16_f32 v66, v52, v53
    v_cvt_pk_bf16_f32 v67, v54, v55
    v_mfma_f32_32x32x16_bf16 v[88:103], v[84:87], v[68:71], v[88:103]
    v_exp_f32 v56, v56
    v_exp_f32 v57, v57
    v_exp_f32 v58, v58
    v_exp_f32 v59, v59
    v_cvt_pk_bf16_f32 v68, v56, v57
    v_cvt_pk_bf16_f32 v69, v58, v59
    v_mfma_f32_32x32x16_bf16 v[104:119], v[80:83], v[64:67], v[104:119]
    ds_read_b128 v[80:83], v13 offset:10240
    v_exp_f32 v60, v60
    v_exp_f32 v61, v61
    v_exp_f32 v62, v62
    v_exp_f32 v63, v63
    s_setprio 0
    v_cvt_pk_bf16_f32 v70, v60, v61
    v_cvt_pk_bf16_f32 v71, v62, v63
    v_mfma_f32_32x32x16_bf16 v[48:63], v[72:75], v[24:27], 0
    ds_read_b128 v[72:75], v13 offset:12288
    v_exp_f32 v32, v32
    v_exp_f32 v33, v33
    v_exp_f32 v34, v34
    v_exp_f32 v35, v35
    v_cvt_pk_bf16_f32 v64, v32, v33
    v_cvt_pk_bf16_f32 v65, v34, v35
    v_mfma_f32_32x32x16_bf16 v[48:63], v[76:79], v[28:31], v[48:63]
    ds_read_b128 v[76:79], v13 offset:13312
    v_exp_f32 v36, v36
    v_exp_f32 v37, v37
    v_exp_f32 v38, v38
    v_exp_f32 v39, v39
    v_cvt_pk_bf16_f32 v66, v36, v37
    v_cvt_pk_bf16_f32 v67, v38, v39
    v_mfma_f32_32x32x16_bf16 v[104:119], v[84:87], v[68:71], v[104:119]
    ds_read_b128 v[84:87], v13 offset:11264
    v_exp_f32 v40, v40
    v_exp_f32 v41, v41
    v_exp_f32 v42, v42
    v_exp_f32 v43, v43
    s_waitcnt lgkmcnt(3)
    v_cvt_pk_bf16_f32 v68, v40, v41
    v_cvt_pk_bf16_f32 v69, v42, v43
    v_mfma_f32_32x32x16_bf16 v[88:103], v[80:83], v[64:67], v[88:103]
    v_exp_f32 v44, v44
    v_exp_f32 v45, v45
    v_exp_f32 v46, v46
    v_exp_f32 v47, v47
    s_waitcnt lgkmcnt(2)
    s_setprio 0
    v_cvt_pk_bf16_f32 v70, v44, v45
    v_cvt_pk_bf16_f32 v71, v46, v47
    v_mfma_f32_32x32x16_bf16 v[32:47], v[72:75], v[16:19], 0
    v_exp_f32 v48, v48
    v_exp_f32 v49, v49
    v_exp_f32 v50, v50
    v_exp_f32 v51, v51
    s_waitcnt lgkmcnt(1)
    v_cvt_pk_bf16_f32 v64, v48, v49
    v_cvt_pk_bf16_f32 v65, v50, v51
    v_mfma_f32_32x32x16_bf16 v[32:47], v[76:79], v[20:23], v[32:47]
    v_exp_f32 v52, v52
    v_exp_f32 v53, v53
    v_exp_f32 v54, v54
    v_exp_f32 v55, v55
    s_waitcnt lgkmcnt(0)
    v_cvt_pk_bf16_f32 v66, v52, v53
    v_cvt_pk_bf16_f32 v67, v54, v55
    v_mfma_f32_32x32x16_bf16 v[88:103], v[84:87], v[68:71], v[88:103]
    v_exp_f32 v56, v56
    v_exp_f32 v57, v57
    v_exp_f32 v58, v58
    v_exp_f32 v59, v59
    v_cvt_pk_bf16_f32 v68, v56, v57
    v_cvt_pk_bf16_f32 v69, v58, v59
    v_mfma_f32_32x32x16_bf16 v[104:119], v[80:83], v[64:67], v[104:119]
    ds_read_b128 v[80:83], v13 offset:14336
    v_exp_f32 v60, v60
    v_exp_f32 v61, v61
    v_exp_f32 v62, v62
    v_exp_f32 v63, v63
    s_setprio 3
    v_cvt_pk_bf16_f32 v70, v60, v61
    v_cvt_pk_bf16_f32 v71, v62, v63
    s_waitcnt vmcnt(0)
    s_barrier
    v_mfma_f32_32x32x16_bf16 v[48:63], v[72:75], v[24:27], 0
    ds_read_b128 v[72:75], v9 offset:0
    v_exp_f32 v32, v32
    v_exp_f32 v33, v33
    v_exp_f32 v34, v34
    v_exp_f32 v35, v35
    v_cvt_pk_bf16_f32 v64, v32, v33
    v_cvt_pk_bf16_f32 v65, v34, v35
    v_mfma_f32_32x32x16_bf16 v[48:63], v[76:79], v[28:31], v[48:63]
    ds_read_b128 v[76:79], v9 offset:1024
    v_exp_f32 v36, v36
    v_exp_f32 v37, v37
    s_add_u32 s70, s6, 7
    s_and_b32 s70, s70, 7
    s_lshl_b32 s70, s70, 15
    s_add_u32 m0, s57, 32768
    s_add_u32 s65, s70, 0
    buffer_load_dwordx4 v3, s[36:39], s65 offen sc1 lds
    v_exp_f32 v38, v38
    v_exp_f32 v39, v39
    v_cvt_pk_bf16_f32 v66, v36, v37
    v_cvt_pk_bf16_f32 v67, v38, v39
    v_mfma_f32_32x32x16_bf16 v[104:119], v[84:87], v[68:71], v[104:119]
    ds_read_b128 v[84:87], v13 offset:15360
    v_exp_f32 v40, v40
    v_exp_f32 v41, v41
    v_exp_f32 v42, v42
    v_exp_f32 v43, v43
    s_waitcnt lgkmcnt(3)
    v_cvt_pk_bf16_f32 v68, v40, v41
    v_cvt_pk_bf16_f32 v69, v42, v43
    v_mfma_f32_32x32x16_bf16 v[88:103], v[80:83], v[64:67], v[88:103]
    v_exp_f32 v44, v44
    v_exp_f32 v45, v45
    v_exp_f32 v46, v46
    v_exp_f32 v47, v47
    s_waitcnt lgkmcnt(2)
    s_setprio 3
    v_cvt_pk_bf16_f32 v70, v44, v45
    v_cvt_pk_bf16_f32 v71, v46, v47
    v_mfma_f32_32x32x16_bf16 v[32:47], v[72:75], v[16:19], 0
    v_exp_f32 v48, v48
    v_exp_f32 v49, v49
    v_exp_f32 v50, v50
    v_exp_f32 v51, v51
    s_waitcnt lgkmcnt(1)
    v_cvt_pk_bf16_f32 v64, v48, v49
    v_cvt_pk_bf16_f32 v65, v50, v51
    v_mfma_f32_32x32x16_bf16 v[32:47], v[76:79], v[20:23], v[32:47]
    v_exp_f32 v52, v52
    v_exp_f32 v53, v53
    s_add_u32 m0, s57, 40960
    s_add_u32 s65, s70, 8192
    buffer_load_dwordx4 v3, s[36:39], s65 offen sc1 lds
    v_exp_f32 v54, v54
    v_exp_f32 v55, v55
    s_waitcnt lgkmcnt(0)
    v_cvt_pk_bf16_f32 v66, v52, v53
    v_cvt_pk_bf16_f32 v67, v54, v55
    v_mfma_f32_32x32x16_bf16 v[88:103], v[84:87], v[68:71], v[88:103]
    v_exp_f32 v56, v56
    v_exp_f32 v57, v57
    v_exp_f32 v58, v58
    v_exp_f32 v59, v59
    v_cvt_pk_bf16_f32 v68, v56, v57
    v_cvt_pk_bf16_f32 v69, v58, v59
    v_mfma_f32_32x32x16_bf16 v[104:119], v[80:83], v[64:67], v[104:119]
    ds_read_b128 v[80:83], v9 offset:2048
    v_exp_f32 v60, v60
    v_exp_f32 v61, v61
    v_exp_f32 v62, v62
    v_exp_f32 v63, v63
    s_setprio 2
    v_cvt_pk_bf16_f32 v70, v60, v61
    v_cvt_pk_bf16_f32 v71, v62, v63
    v_mfma_f32_32x32x16_bf16 v[48:63], v[72:75], v[24:27], 0
    ds_read_b128 v[72:75], v9 offset:4096
    v_exp_f32 v32, v32
    v_exp_f32 v33, v33
    v_exp_f32 v34, v34
    v_exp_f32 v35, v35
    v_cvt_pk_bf16_f32 v64, v32, v33
    v_cvt_pk_bf16_f32 v65, v34, v35
    v_mfma_f32_32x32x16_bf16 v[48:63], v[76:79], v[28:31], v[48:63]
    ds_read_b128 v[76:79], v9 offset:5120
    v_exp_f32 v36, v36
    v_exp_f32 v37, v37
    s_add_u32 m0, s57, 49152
    s_add_u32 s65, s70, 16384
    buffer_load_dwordx4 v3, s[36:39], s65 offen sc1 lds
    v_exp_f32 v38, v38
    v_exp_f32 v39, v39
    v_cvt_pk_bf16_f32 v66, v36, v37
    v_cvt_pk_bf16_f32 v67, v38, v39
    v_mfma_f32_32x32x16_bf16 v[104:119], v[84:87], v[68:71], v[104:119]
    ds_read_b128 v[84:87], v9 offset:3072
    v_exp_f32 v40, v40
    v_exp_f32 v41, v41
    v_exp_f32 v42, v42
    v_exp_f32 v43, v43
    s_waitcnt lgkmcnt(3)
    v_cvt_pk_bf16_f32 v68, v40, v41
    v_cvt_pk_bf16_f32 v69, v42, v43
    v_mfma_f32_32x32x16_bf16 v[88:103], v[80:83], v[64:67], v[88:103]
    v_exp_f32 v44, v44
    v_exp_f32 v45, v45
    v_exp_f32 v46, v46
    v_exp_f32 v47, v47
    s_waitcnt lgkmcnt(2)
    s_setprio 2
    v_cvt_pk_bf16_f32 v70, v44, v45
    v_cvt_pk_bf16_f32 v71, v46, v47
    v_mfma_f32_32x32x16_bf16 v[32:47], v[72:75], v[16:19], 0
    v_exp_f32 v48, v48
    v_exp_f32 v49, v49
    v_exp_f32 v50, v50
    v_exp_f32 v51, v51
    s_waitcnt lgkmcnt(1)
    v_cvt_pk_bf16_f32 v64, v48, v49
    v_cvt_pk_bf16_f32 v65, v50, v51
    v_mfma_f32_32x32x16_bf16 v[32:47], v[76:79], v[20:23], v[32:47]
    v_exp_f32 v52, v52
    v_exp_f32 v53, v53
    s_add_u32 m0, s57, 57344
    s_add_u32 s65, s70, 24576
    buffer_load_dwordx4 v3, s[36:39], s65 offen sc1 lds
    v_exp_f32 v54, v54
    v_exp_f32 v55, v55
    s_waitcnt lgkmcnt(0)
    v_cvt_pk_bf16_f32 v66, v52, v53
    v_cvt_pk_bf16_f32 v67, v54, v55
    v_mfma_f32_32x32x16_bf16 v[88:103], v[84:87], v[68:71], v[88:103]
    v_exp_f32 v56, v56
    v_exp_f32 v57, v57
    v_exp_f32 v58, v58
    v_exp_f32 v59, v59
    v_cvt_pk_bf16_f32 v68, v56, v57
    v_cvt_pk_bf16_f32 v69, v58, v59
    v_mfma_f32_32x32x16_bf16 v[104:119], v[80:83], v[64:67], v[104:119]
    ds_read_b128 v[80:83], v9 offset:6144
    v_exp_f32 v60, v60
    v_exp_f32 v61, v61
    v_exp_f32 v62, v62
    v_exp_f32 v63, v63
    s_setprio 1
    v_cvt_pk_bf16_f32 v70, v60, v61
    v_cvt_pk_bf16_f32 v71, v62, v63
    v_mfma_f32_32x32x16_bf16 v[48:63], v[72:75], v[24:27], 0
    ds_read_b128 v[72:75], v9 offset:8192
    v_exp_f32 v32, v32
    v_exp_f32 v33, v33
    v_exp_f32 v34, v34
    v_exp_f32 v35, v35
    v_cvt_pk_bf16_f32 v64, v32, v33
    v_cvt_pk_bf16_f32 v65, v34, v35
    v_mfma_f32_32x32x16_bf16 v[48:63], v[76:79], v[28:31], v[48:63]
    ds_read_b128 v[76:79], v9 offset:9216
    v_exp_f32 v36, v36
    v_exp_f32 v37, v37
    s_mul_i32 s65, s9, 50176
    s_add_u32 s65, s65, s56
    v_mul_u32_u24 v5, 896, v1
    s_mov_b32 exec_lo, -1
    s_mov_b32 exec_hi, 0xffffff
    buffer_load_dword v11, v5, s[44:47], s65 offen
    s_mov_b64 exec, -1
    v_exp_f32 v38, v38
    v_exp_f32 v39, v39
    v_cvt_pk_bf16_f32 v66, v36, v37
    v_cvt_pk_bf16_f32 v67, v38, v39
    v_mfma_f32_32x32x16_bf16 v[104:119], v[84:87], v[68:71], v[104:119]
    ds_read_b128 v[84:87], v9 offset:7168
    v_exp_f32 v40, v40
    v_exp_f32 v41, v41
    v_exp_f32 v42, v42
    v_exp_f32 v43, v43
    s_waitcnt lgkmcnt(3)
    v_cvt_pk_bf16_f32 v68, v40, v41
    v_cvt_pk_bf16_f32 v69, v42, v43
    v_mfma_f32_32x32x16_bf16 v[88:103], v[80:83], v[64:67], v[88:103]
    v_exp_f32 v44, v44
    v_exp_f32 v45, v45
    v_exp_f32 v46, v46
    v_exp_f32 v47, v47
    s_waitcnt lgkmcnt(2)
    s_setprio 1
    v_cvt_pk_bf16_f32 v70, v44, v45
    v_cvt_pk_bf16_f32 v71, v46, v47
    v_mfma_f32_32x32x16_bf16 v[32:47], v[72:75], v[16:19], 0
    v_exp_f32 v48, v48
    v_exp_f32 v49, v49
    v_exp_f32 v50, v50
    v_exp_f32 v51, v51
    s_waitcnt lgkmcnt(1)
    v_cvt_pk_bf16_f32 v64, v48, v49
    v_cvt_pk_bf16_f32 v65, v50, v51
    v_mfma_f32_32x32x16_bf16 v[32:47], v[76:79], v[20:23], v[32:47]
    v_exp_f32 v52, v52
    v_exp_f32 v53, v53
    v_exp_f32 v54, v54
    v_exp_f32 v55, v55
    s_waitcnt lgkmcnt(0)
    v_cvt_pk_bf16_f32 v66, v52, v53
    v_cvt_pk_bf16_f32 v67, v54, v55
    v_mfma_f32_32x32x16_bf16 v[88:103], v[84:87], v[68:71], v[88:103]
    v_exp_f32 v56, v56
    v_exp_f32 v57, v57
    v_exp_f32 v58, v58
    v_exp_f32 v59, v59
    v_cvt_pk_bf16_f32 v68, v56, v57
    v_cvt_pk_bf16_f32 v69, v58, v59
    v_mfma_f32_32x32x16_bf16 v[104:119], v[80:83], v[64:67], v[104:119]
    ds_read_b128 v[80:83], v9 offset:10240
    v_exp_f32 v60, v60
    v_exp_f32 v61, v61
    v_exp_f32 v62, v62
    v_exp_f32 v63, v63
    s_setprio 0
    v_cvt_pk_bf16_f32 v70, v60, v61
    v_cvt_pk_bf16_f32 v71, v62, v63
    v_mfma_f32_32x32x16_bf16 v[48:63], v[72:75], v[24:27], 0
    ds_read_b128 v[72:75], v9 offset:12288
    v_exp_f32 v32, v32
    v_exp_f32 v33, v33
    v_exp_f32 v34, v34
    v_exp_f32 v35, v35
    v_cvt_pk_bf16_f32 v64, v32, v33
    v_cvt_pk_bf16_f32 v65, v34, v35
    v_mfma_f32_32x32x16_bf16 v[48:63], v[76:79], v[28:31], v[48:63]
    ds_read_b128 v[76:79], v9 offset:13312
    v_exp_f32 v36, v36
    v_exp_f32 v37, v37
    v_exp_f32 v38, v38
    v_exp_f32 v39, v39
    v_cvt_pk_bf16_f32 v66, v36, v37
    v_cvt_pk_bf16_f32 v67, v38, v39
    v_mfma_f32_32x32x16_bf16 v[104:119], v[84:87], v[68:71], v[104:119]
    ds_read_b128 v[84:87], v9 offset:11264
    v_exp_f32 v40, v40
    v_exp_f32 v41, v41
    v_exp_f32 v42, v42
    v_exp_f32 v43, v43
    s_waitcnt lgkmcnt(3)
    v_cvt_pk_bf16_f32 v68, v40, v41
    v_cvt_pk_bf16_f32 v69, v42, v43
    v_mfma_f32_32x32x16_bf16 v[88:103], v[80:83], v[64:67], v[88:103]
    v_exp_f32 v44, v44
    v_exp_f32 v45, v45
    v_exp_f32 v46, v46
    v_exp_f32 v47, v47
    s_waitcnt lgkmcnt(2)
    s_setprio 0
    v_cvt_pk_bf16_f32 v70, v44, v45
    v_cvt_pk_bf16_f32 v71, v46, v47
    v_mfma_f32_32x32x16_bf16 v[32:47], v[72:75], v[16:19], 0
    v_exp_f32 v48, v48
    v_exp_f32 v49, v49
    v_exp_f32 v50, v50
    v_exp_f32 v51, v51
    s_waitcnt lgkmcnt(1)
    v_cvt_pk_bf16_f32 v64, v48, v49
    v_cvt_pk_bf16_f32 v65, v50, v51
    v_mfma_f32_32x32x16_bf16 v[32:47], v[76:79], v[20:23], v[32:47]
    v_exp_f32 v52, v52
    v_exp_f32 v53, v53
    v_exp_f32 v54, v54
    v_exp_f32 v55, v55
    s_waitcnt lgkmcnt(0)
    v_cvt_pk_bf16_f32 v66, v52, v53
    v_cvt_pk_bf16_f32 v67, v54, v55
    v_mfma_f32_32x32x16_bf16 v[88:103], v[84:87], v[68:71], v[88:103]
    v_exp_f32 v56, v56
    v_exp_f32 v57, v57
    v_exp_f32 v58, v58
    v_exp_f32 v59, v59
    v_cvt_pk_bf16_f32 v68, v56, v57
    v_cvt_pk_bf16_f32 v69, v58, v59
    v_mfma_f32_32x32x16_bf16 v[104:119], v[80:83], v[64:67], v[104:119]
    ds_read_b128 v[80:83], v9 offset:14336
    v_exp_f32 v60, v60
    v_exp_f32 v61, v61
    v_exp_f32 v62, v62
    v_exp_f32 v63, v63
    s_setprio 3
    v_cvt_pk_bf16_f32 v70, v60, v61
    v_cvt_pk_bf16_f32 v71, v62, v63
    s_waitcnt vmcnt(0)
    s_barrier
    v_mfma_f32_32x32x16_bf16 v[48:63], v[72:75], v[24:27], 0
    ds_read_b128 v[72:75], v9 offset:32768
    v_exp_f32 v32, v32
    v_exp_f32 v33, v33
    v_exp_f32 v34, v34
    v_exp_f32 v35, v35
    v_cvt_pk_bf16_f32 v64, v32, v33
    v_cvt_pk_bf16_f32 v65, v34, v35
    v_mfma_f32_32x32x16_bf16 v[48:63], v[76:79], v[28:31], v[48:63]
    ds_read_b128 v[76:79], v9 offset:33792
    v_exp_f32 v36, v36
    v_exp_f32 v37, v37
    s_add_u32 s65, s9, 0
    s_lshl_b32 s66, s65, 10
    s_add_u32 m0, s66, 65536
    s_mul_i32 s65, s65, 7168
    s_add_u32 s65, s65, 0
    s_add_u32 s65, s65, s56
    buffer_load_dwordx4 v15, s[44:47], s65 offen lds
    v_exp_f32 v38, v38
    v_exp_f32 v39, v39
    v_cvt_pk_bf16_f32 v66, v36, v37
    v_cvt_pk_bf16_f32 v67, v38, v39
    v_mfma_f32_32x32x16_bf16 v[104:119], v[84:87], v[68:71], v[104:119]
    ds_read_b128 v[84:87], v9 offset:15360
    v_exp_f32 v40, v40
    v_exp_f32 v41, v41
    v_exp_f32 v42, v42
    v_exp_f32 v43, v43
    s_waitcnt lgkmcnt(3)
    v_cvt_pk_bf16_f32 v68, v40, v41
    v_cvt_pk_bf16_f32 v69, v42, v43
    v_mfma_f32_32x32x16_bf16 v[88:103], v[80:83], v[64:67], v[88:103]
    v_exp_f32 v44, v44
    v_exp_f32 v45, v45
    v_exp_f32 v46, v46
    v_exp_f32 v47, v47
    s_waitcnt lgkmcnt(2)
    s_setprio 3
    v_cvt_pk_bf16_f32 v70, v44, v45
    v_cvt_pk_bf16_f32 v71, v46, v47
    v_mfma_f32_32x32x16_bf16 v[32:47], v[72:75], v[16:19], 0
    v_exp_f32 v48, v48
    v_exp_f32 v49, v49
    v_exp_f32 v50, v50
    v_exp_f32 v51, v51
    s_waitcnt lgkmcnt(1)
    v_cvt_pk_bf16_f32 v64, v48, v49
    v_cvt_pk_bf16_f32 v65, v50, v51
    v_mfma_f32_32x32x16_bf16 v[32:47], v[76:79], v[20:23], v[32:47]
    v_exp_f32 v52, v52
    v_exp_f32 v53, v53
    s_add_u32 s65, s9, 8
    s_lshl_b32 s66, s65, 10
    s_add_u32 m0, s66, 65536
    s_mul_i32 s65, s65, 7168
    s_add_u32 s65, s65, 0
    s_add_u32 s65, s65, s56
    buffer_load_dwordx4 v15, s[44:47], s65 offen lds
    v_exp_f32 v54, v54
    v_exp_f32 v55, v55
    s_waitcnt lgkmcnt(0)
    v_cvt_pk_bf16_f32 v66, v52, v53
    v_cvt_pk_bf16_f32 v67, v54, v55
    v_mfma_f32_32x32x16_bf16 v[88:103], v[84:87], v[68:71], v[88:103]
    v_exp_f32 v56, v56
    v_exp_f32 v57, v57
    v_exp_f32 v58, v58
    v_exp_f32 v59, v59
    v_cvt_pk_bf16_f32 v68, v56, v57
    v_cvt_pk_bf16_f32 v69, v58, v59
    v_mfma_f32_32x32x16_bf16 v[104:119], v[80:83], v[64:67], v[104:119]
    ds_read_b128 v[80:83], v9 offset:34816
    v_exp_f32 v60, v60
    v_exp_f32 v61, v61
    v_exp_f32 v62, v62
    v_exp_f32 v63, v63
    s_setprio 3
    v_cvt_pk_bf16_f32 v70, v60, v61
    v_cvt_pk_bf16_f32 v71, v62, v63
    v_mfma_f32_32x32x16_bf16 v[48:63], v[72:75], v[24:27], 0
    ds_read_b128 v[72:75], v9 offset:36864
    v_exp_f32 v32, v32
    v_exp_f32 v33, v33
    v_exp_f32 v34, v34
    v_exp_f32 v35, v35
    v_cvt_pk_bf16_f32 v64, v32, v33
    v_cvt_pk_bf16_f32 v65, v34, v35
    v_mfma_f32_32x32x16_bf16 v[48:63], v[76:79], v[28:31], v[48:63]
    ds_read_b128 v[76:79], v9 offset:37888
    v_exp_f32 v36, v36
    v_exp_f32 v37, v37
    s_add_u32 s65, s9, 16
    s_lshl_b32 s66, s65, 10
    s_add_u32 m0, s66, 65536
    s_mul_i32 s65, s65, 7168
    s_add_u32 s65, s65, 0
    s_add_u32 s65, s65, s56
    buffer_load_dwordx4 v15, s[44:47], s65 offen lds
    v_exp_f32 v38, v38
    v_exp_f32 v39, v39
    v_cvt_pk_bf16_f32 v66, v36, v37
    v_cvt_pk_bf16_f32 v67, v38, v39
    v_mfma_f32_32x32x16_bf16 v[104:119], v[84:87], v[68:71], v[104:119]
    ds_read_b128 v[84:87], v9 offset:35840
    v_exp_f32 v40, v40
    v_exp_f32 v41, v41
    v_exp_f32 v42, v42
    v_exp_f32 v43, v43
    s_waitcnt lgkmcnt(3)
    v_cvt_pk_bf16_f32 v68, v40, v41
    v_cvt_pk_bf16_f32 v69, v42, v43
    v_mfma_f32_32x32x16_bf16 v[88:103], v[80:83], v[64:67], v[88:103]
    v_exp_f32 v44, v44
    v_exp_f32 v45, v45
    v_exp_f32 v46, v46
    v_exp_f32 v47, v47
    s_waitcnt lgkmcnt(2)
    s_setprio 2
    v_cvt_pk_bf16_f32 v70, v44, v45
    v_cvt_pk_bf16_f32 v71, v46, v47
    v_mfma_f32_32x32x16_bf16 v[32:47], v[72:75], v[16:19], 0
    v_exp_f32 v48, v48
    v_exp_f32 v49, v49
    v_exp_f32 v50, v50
    v_exp_f32 v51, v51
    s_waitcnt lgkmcnt(1)
    v_cvt_pk_bf16_f32 v64, v48, v49
    v_cvt_pk_bf16_f32 v65, v50, v51
    v_mfma_f32_32x32x16_bf16 v[32:47], v[76:79], v[20:23], v[32:47]
    v_exp_f32 v52, v52
    v_exp_f32 v53, v53
    s_add_u32 s65, s9, 24
    s_cmp_ge_u32 s65, 29
    s_cselect_b32 s66, 29, 0
    s_sub_u32 s65, s65, s66
    s_lshl_b32 s66, s65, 10
    s_add_u32 m0, s66, 65536
    s_mul_i32 s65, s65, 7168
    s_add_u32 s65, s65, 0
    s_add_u32 s65, s65, s56
    buffer_load_dwordx4 v15, s[44:47], s65 offen lds
    v_exp_f32 v54, v54
    v_exp_f32 v55, v55
    s_waitcnt lgkmcnt(0)
    v_cvt_pk_bf16_f32 v66, v52, v53
    v_cvt_pk_bf16_f32 v67, v54, v55
    v_mfma_f32_32x32x16_bf16 v[88:103], v[84:87], v[68:71], v[88:103]
    v_exp_f32 v56, v56
    v_exp_f32 v57, v57
    v_exp_f32 v58, v58
    v_exp_f32 v59, v59
    v_cvt_pk_bf16_f32 v68, v56, v57
    v_cvt_pk_bf16_f32 v69, v58, v59
    v_mfma_f32_32x32x16_bf16 v[104:119], v[80:83], v[64:67], v[104:119]
    ds_read_b128 v[80:83], v9 offset:38912
    v_exp_f32 v60, v60
    v_exp_f32 v61, v61
    v_exp_f32 v62, v62
    v_exp_f32 v63, v63
    s_setprio 2
    v_cvt_pk_bf16_f32 v70, v60, v61
    v_cvt_pk_bf16_f32 v71, v62, v63
    s_barrier
    v_mfma_f32_32x32x16_bf16 v[48:63], v[72:75], v[24:27], 0
    ds_read_b128 v[72:75], v9 offset:40960
    v_exp_f32 v32, v32
    v_exp_f32 v33, v33
    v_exp_f32 v34, v34
    v_exp_f32 v35, v35
    v_cvt_pk_bf16_f32 v64, v32, v33
    v_cvt_pk_bf16_f32 v65, v34, v35
    v_mfma_f32_32x32x16_bf16 v[48:63], v[76:79], v[28:31], v[48:63]
    ds_read_b128 v[76:79], v9 offset:41984
    v_exp_f32 v36, v36
    v_exp_f32 v37, v37
    v_exp_f32 v38, v38
    v_exp_f32 v39, v39
    v_cvt_pk_bf16_f32 v66, v36, v37
    v_cvt_pk_bf16_f32 v67, v38, v39
    v_mfma_f32_32x32x16_bf16 v[104:119], v[84:87], v[68:71], v[104:119]
    ds_read_b128 v[84:87], v9 offset:39936
    v_exp_f32 v40, v40
    v_exp_f32 v41, v41
    v_exp_f32 v42, v42
    v_exp_f32 v43, v43
    s_waitcnt lgkmcnt(3)
    v_cvt_pk_bf16_f32 v68, v40, v41
    v_cvt_pk_bf16_f32 v69, v42, v43
    v_mfma_f32_32x32x16_bf16 v[88:103], v[80:83], v[64:67], v[88:103]
    v_exp_f32 v44, v44
    v_exp_f32 v45, v45
    v_exp_f32 v46, v46
    v_exp_f32 v47, v47
    s_waitcnt lgkmcnt(2)
    s_setprio 1
    v_cvt_pk_bf16_f32 v70, v44, v45
    v_cvt_pk_bf16_f32 v71, v46, v47
    v_mfma_f32_32x32x16_bf16 v[32:47], v[72:75], v[16:19], 0
    v_exp_f32 v48, v48
    v_exp_f32 v49, v49
    v_exp_f32 v50, v50
    v_exp_f32 v51, v51
    s_waitcnt lgkmcnt(1)
    v_cvt_pk_bf16_f32 v64, v48, v49
    v_cvt_pk_bf16_f32 v65, v50, v51
    v_mfma_f32_32x32x16_bf16 v[32:47], v[76:79], v[20:23], v[32:47]
    v_exp_f32 v52, v52
    v_exp_f32 v53, v53
    v_exp_f32 v54, v54
    v_exp_f32 v55, v55
    s_waitcnt lgkmcnt(0)
    v_cvt_pk_bf16_f32 v66, v52, v53
    v_cvt_pk_bf16_f32 v67, v54, v55
    v_mfma_f32_32x32x16_bf16 v[88:103], v[84:87], v[68:71], v[88:103]
    v_exp_f32 v56, v56
    v_exp_f32 v57, v57
    v_exp_f32 v58, v58
    v_exp_f32 v59, v59
    v_cvt_pk_bf16_f32 v68, v56, v57
    v_cvt_pk_bf16_f32 v69, v58, v59
    v_mfma_f32_32x32x16_bf16 v[104:119], v[80:83], v[64:67], v[104:119]
    ds_read_b128 v[80:83], v9 offset:43008
    v_exp_f32 v60, v60
    v_exp_f32 v61, v61
    v_exp_f32 v62, v62
    v_exp_f32 v63, v63
    s_setprio 1
    v_cvt_pk_bf16_f32 v70, v60, v61
    v_cvt_pk_bf16_f32 v71, v62, v63
    v_mfma_f32_32x32x16_bf16 v[48:63], v[72:75], v[24:27], 0
    ds_read_b128 v[72:75], v9 offset:45056
    v_exp_f32 v32, v32
    v_exp_f32 v33, v33
    v_exp_f32 v34, v34
    v_exp_f32 v35, v35
    v_cvt_pk_bf16_f32 v64, v32, v33
    v_cvt_pk_bf16_f32 v65, v34, v35
    v_mfma_f32_32x32x16_bf16 v[48:63], v[76:79], v[28:31], v[48:63]
    ds_read_b128 v[76:79], v9 offset:46080
    v_exp_f32 v36, v36
    v_exp_f32 v37, v37
    v_exp_f32 v38, v38
    v_exp_f32 v39, v39
    v_cvt_pk_bf16_f32 v66, v36, v37
    v_cvt_pk_bf16_f32 v67, v38, v39
    v_mfma_f32_32x32x16_bf16 v[104:119], v[84:87], v[68:71], v[104:119]
    ds_read_b128 v[84:87], v9 offset:44032
    v_exp_f32 v40, v40
    v_exp_f32 v41, v41
    v_exp_f32 v42, v42
    v_exp_f32 v43, v43
    s_waitcnt lgkmcnt(3)
    v_cvt_pk_bf16_f32 v68, v40, v41
    v_cvt_pk_bf16_f32 v69, v42, v43
    v_mfma_f32_32x32x16_bf16 v[88:103], v[80:83], v[64:67], v[88:103]
    v_exp_f32 v44, v44
    v_exp_f32 v45, v45
    v_exp_f32 v46, v46
    v_exp_f32 v47, v47
    s_waitcnt lgkmcnt(2)
    s_setprio 1
    v_cvt_pk_bf16_f32 v70, v44, v45
    v_cvt_pk_bf16_f32 v71, v46, v47
    v_mfma_f32_32x32x16_bf16 v[32:47], v[72:75], v[16:19], 0
    v_exp_f32 v48, v48
    v_exp_f32 v49, v49
    v_exp_f32 v50, v50
    v_exp_f32 v51, v51
    s_waitcnt lgkmcnt(1)
    v_cvt_pk_bf16_f32 v64, v48, v49
    v_cvt_pk_bf16_f32 v65, v50, v51
    v_mfma_f32_32x32x16_bf16 v[32:47], v[76:79], v[20:23], v[32:47]
    v_exp_f32 v52, v52
    v_exp_f32 v53, v53
    v_exp_f32 v54, v54
    v_exp_f32 v55, v55
    s_waitcnt lgkmcnt(0)
    v_cvt_pk_bf16_f32 v66, v52, v53
    v_cvt_pk_bf16_f32 v67, v54, v55
    v_mfma_f32_32x32x16_bf16 v[88:103], v[84:87], v[68:71], v[88:103]
    v_exp_f32 v56, v56
    v_exp_f32 v57, v57
    v_exp_f32 v58, v58
    v_exp_f32 v59, v59
    v_cvt_pk_bf16_f32 v68, v56, v57
    v_cvt_pk_bf16_f32 v69, v58, v59
    v_mfma_f32_32x32x16_bf16 v[104:119], v[80:83], v[64:67], v[104:119]
    ds_read_b128 v[80:83], v9 offset:47104
    v_exp_f32 v60, v60
    v_exp_f32 v61, v61
    v_exp_f32 v62, v62
    v_exp_f32 v63, v63
    s_setprio 0
    v_cvt_pk_bf16_f32 v70, v60, v61
    v_cvt_pk_bf16_f32 v71, v62, v63
    v_mfma_f32_32x32x16_bf16 v[48:63], v[72:75], v[24:27], 0
    v_exp_f32 v32, v32
    v_exp_f32 v33, v33
    v_exp_f32 v34, v34
    v_exp_f32 v35, v35
    v_cvt_pk_bf16_f32 v64, v32, v33
    v_cvt_pk_bf16_f32 v65, v34, v35
    v_mfma_f32_32x32x16_bf16 v[48:63], v[76:79], v[28:31], v[48:63]
    v_exp_f32 v36, v36
    v_exp_f32 v37, v37
    v_exp_f32 v38, v38
    v_exp_f32 v39, v39
    v_cvt_pk_bf16_f32 v66, v36, v37
    v_cvt_pk_bf16_f32 v67, v38, v39
    v_mfma_f32_32x32x16_bf16 v[104:119], v[84:87], v[68:71], v[104:119]
    ds_read_b128 v[84:87], v9 offset:48128
    v_exp_f32 v40, v40
    v_exp_f32 v41, v41
    v_exp_f32 v42, v42
    v_exp_f32 v43, v43
    s_waitcnt lgkmcnt(1)
    v_cvt_pk_bf16_f32 v68, v40, v41
    v_cvt_pk_bf16_f32 v69, v42, v43
    v_mfma_f32_32x32x16_bf16 v[88:103], v[80:83], v[64:67], v[88:103]
    v_exp_f32 v44, v44
    v_exp_f32 v45, v45
    v_exp_f32 v46, v46
    v_exp_f32 v47, v47
    s_setprio 0
    v_cvt_pk_bf16_f32 v70, v44, v45
    v_cvt_pk_bf16_f32 v71, v46, v47
    v_exp_f32 v48, v48
    v_exp_f32 v49, v49
    v_exp_f32 v50, v50
    v_exp_f32 v51, v51
    v_cvt_pk_bf16_f32 v64, v48, v49
    v_cvt_pk_bf16_f32 v65, v50, v51
    v_exp_f32 v52, v52
    v_exp_f32 v53, v53
    v_exp_f32 v54, v54
    v_exp_f32 v55, v55
    s_waitcnt lgkmcnt(0)
    v_cvt_pk_bf16_f32 v66, v52, v53
    v_cvt_pk_bf16_f32 v67, v54, v55
    v_mfma_f32_32x32x16_bf16 v[88:103], v[84:87], v[68:71], v[88:103]
    v_exp_f32 v56, v56
    v_exp_f32 v57, v57
    v_exp_f32 v58, v58
    v_exp_f32 v59, v59
    v_cvt_pk_bf16_f32 v68, v56, v57
    v_cvt_pk_bf16_f32 v69, v58, v59
    v_mfma_f32_32x32x16_bf16 v[104:119], v[80:83], v[64:67], v[104:119]
    v_exp_f32 v60, v60
    v_exp_f32 v61, v61
    v_exp_f32 v62, v62
    v_exp_f32 v63, v63
    v_cvt_pk_bf16_f32 v70, v60, v61
    v_cvt_pk_bf16_f32 v71, v62, v63
    s_setprio 0
    s_nop 1
    v_mfma_f32_32x32x16_bf16 v[104:119], v[84:87], v[68:71], v[104:119]
    s_nop 15
    s_lshl_b32 s3, s9, 12
    v_add_u32 v6, s3, v2
    ds_write_b128 v6, v[104:107] offset:0
    ds_write_b128 v6, v[108:111] offset:1024
    ds_write_b128 v6, v[112:115] offset:2048
    ds_write_b128 v6, v[116:119] offset:3072
    v_xor_b32 v6, 16384, v6
    s_waitcnt lgkmcnt(0)
    s_barrier
    ds_read_b128 v[104:107], v6 offset:0
    ds_read_b128 v[108:111], v6 offset:1024
    ds_read_b128 v[112:115], v6 offset:2048
    ds_read_b128 v[116:119], v6 offset:3072
    s_add_u32 s65, s9, 0
    s_lshl_b32 s66, s65, 10
    s_add_u32 m0, s66, 32768
    s_mul_i32 s65, s65, 7168
    s_add_u32 s65, s65, 200704
    s_add_u32 s65, s65, s56
    buffer_load_dwordx4 v15, s[44:47], s65 offen lds
    s_add_u32 s65, s9, 8
    s_lshl_b32 s66, s65, 10
    s_add_u32 m0, s66, 32768
    s_mul_i32 s65, s65, 7168
    s_add_u32 s65, s65, 200704
    s_add_u32 s65, s65, s56
    buffer_load_dwordx4 v15, s[44:47], s65 offen lds
    s_add_u32 s65, s9, 16
    s_lshl_b32 s66, s65, 10
    s_add_u32 m0, s66, 32768
    s_mul_i32 s65, s65, 7168
    s_add_u32 s65, s65, 200704
    s_add_u32 s65, s65, s56
    buffer_load_dwordx4 v15, s[44:47], s65 offen lds
    s_add_u32 s65, s9, 24
    s_cmp_ge_u32 s65, 29
    s_cselect_b32 s66, 29, 0
    s_sub_u32 s65, s65, s66
    s_lshl_b32 s66, s65, 10
    s_add_u32 m0, s66, 32768
    s_mul_i32 s65, s65, 7168
    s_add_u32 s65, s65, 200704
    s_add_u32 s65, s65, s56
    buffer_load_dwordx4 v15, s[44:47], s65 offen lds
    s_waitcnt lgkmcnt(0)
    v_add_f32 v88, v88, v104
    v_add_f32 v89, v89, v105
    v_add_f32 v90, v90, v106
    v_add_f32 v91, v91, v107
    v_add_f32 v92, v92, v108
    v_add_f32 v93, v93, v109
    v_add_f32 v94, v94, v110
    v_add_f32 v95, v95, v111
    v_add_f32 v96, v96, v112
    v_add_f32 v97, v97, v113
    v_add_f32 v98, v98, v114
    v_add_f32 v99, v99, v115
    v_add_f32 v100, v100, v116
    v_add_f32 v101, v101, v117
    v_add_f32 v102, v102, v118
    v_add_f32 v103, v103, v119
    s_mov_b32 s70, 0
F_final:
    v_mov_b32 v5, v100
    v_mov_b32 v6, v100
    s_nop 1
    v_permlane32_swap_b32 v5, v6
    v_rcp_f32 v7, v6
    s_lshl_b32 s11, s5, 17
    v_mul_f32 v7, v7, v4
    s_lshl_b32 s3, s6, 3
    s_add_u32 s3, s3, s64
    v_mul_f32 v104, v88, v7
    v_mul_f32 v105, v89, v7
    v_mul_f32 v106, v90, v7
    v_mul_f32 v107, v91, v7
    v_mul_f32 v108, v92, v7
    v_mul_f32 v109, v93, v7
    v_mul_f32 v110, v94, v7
    v_mul_f32 v111, v95, v7
    v_mul_f32 v112, v96, v7
    v_mul_f32 v113, v97, v7
    v_mul_f32 v114, v98, v7
    v_mul_f32 v115, v99, v7
    v_mul_f32 v116, v100, v7
    v_mul_f32 v117, v101, v7
    v_mul_f32 v118, v102, v7
    v_mul_f32 v119, v103, v7
    v_cvt_pk_bf16_f32 v32, v104, v105
    v_cvt_pk_bf16_f32 v33, v106, v107
    v_cvt_pk_bf16_f32 v34, v108, v109
    v_cvt_pk_bf16_f32 v35, v110, v111
    v_cvt_pk_bf16_f32 v36, v112, v113
    v_cvt_pk_bf16_f32 v37, v114, v115
    v_cvt_pk_bf16_f32 v38, v116, v117
    v_cvt_pk_bf16_f32 v39, v118, v119
    s_lshl_b32 s59, s3, 12
    s_add_u32 s59, s59, 16842752
    s_lshl_b32 s3, s3, 11
    s_add_u32 s11, s11, s3
    s_add_u32 s11, s11, 8388608
    s_mov_b64 exec, s[68:69]
    v_mov_b32 v38, 0
    v_mov_b32 v39, 0
    s_mov_b64 exec, -1
    s_lshl_b32 s3, s5, 7
    s_add_u32 s3, s3, s59
    buffer_store_dwordx4 v[32:35], v2, s[52:55], s11 offen sc1
    buffer_store_dwordx4 v[36:39], v2, s[52:55], s11 offen offset:1024 sc1
    s_cmp_lg_u32 s70, 0
    s_cbranch_scc1 F_chkd
    v_mul_f32 v7, 0, v104
    v_fmac_f32 v7, 0, v105
    v_fmac_f32 v7, 0, v106
    v_fmac_f32 v7, 0, v107
    v_fmac_f32 v7, 0, v108
    v_fmac_f32 v7, 0, v109
    v_fmac_f32 v7, 0, v110
    v_fmac_f32 v7, 0, v111
    v_fmac_f32 v7, 0, v112
    v_fmac_f32 v7, 0, v113
    v_fmac_f32 v7, 0, v114
    v_fmac_f32 v7, 0, v115
    v_fmac_f32 v7, 0, v116
    v_fmac_f32 v7, 0, v117
    v_fmac_f32 v7, 0, v118
    v_fmac_f32 v7, 0, v119
    v_cmp_u_f32 vcc, v7, v7
    s_nop 0
    s_or_b64 s[62:63], s[62:63], vcc
    v_cmp_nge_f32 vcc, 0x71800000, v6
    s_nop 0
    s_or_b64 s[62:63], s[62:63], vcc
    v_cmp_nle_f32 vcc, 0x35800000, v6
    s_nop 0
    s_or_b64 s[62:63], s[62:63], vcc
    s_cmp_lg_u64 s[62:63], 0
    s_cbranch_scc1 F_slow
F_chkd:
    s_waitcnt vmcnt(0)
    v_mov_b32 v12, s71
    s_mov_b64 exec, 1
    buffer_store_dword v12, v120, s[52:55], s3 offen sc1
    s_mov_b64 exec, -1
    s_cmp_ge_u32 s5, 28
    s_cbranch_scc1 F_end
    s_and_b32 s60, s9, 1
    s_lshr_b32 s61, s9, 1
    v_lshrrev_b32 v6, 4, v1
    v_and_b32 v7, 1, v6
    v_lshrrev_b32 v6, 1, v6
    v_bfe_u32 v5, v1, 2, 2
    v_lshl_add_u32 v6, v6, 2, v5
    v_lshlrev_b32 v6, 7, v6
    v_lshrrev_b32 v5, 1, v5
    v_lshl_add_u32 v6, v5, 6, v6
    v_lshl_add_u32 v6, v7, 5, v6
    v_and_b32 v7, 3, v1
    v_lshl_add_u32 v6, v7, 3, v6
    s_mul_i32 s62, s61, 29696
    s_add_u32 s62, s62, 98304
    s_cmp_eq_u32 s61, 2
    s_cselect_b32 s62, 65536, s62
    s_mov_b32 s63, 32768
    s_cmp_eq_u32 s61, 3
    s_cselect_b32 s62, s63, s62
    v_add_u32 v14, s62, v6
    v_xor_b32 v15, 64, v14
    s_lshl_b32 s62, s4, 1
    s_add_u32 s62, s62, s60
    s_lshl_b32 s62, s62, 11
    s_lshl_b32 s63, s61, 20
    s_add_u32 s62, s62, s63
    s_add_u32 s62, s62, 8388608
    v_mov_b32 v96, 0
    v_mov_b32 v97, 0
    v_mov_b32 v98, 0
    v_mov_b32 v99, 0
    v_mov_b32 v100, 0
    v_mov_b32 v101, 0
    v_mov_b32 v102, 0
    v_mov_b32 v103, 0
    v_mov_b32 v104, 0
    v_mov_b32 v105, 0
    v_mov_b32 v106, 0
    v_mov_b32 v107, 0
    v_mov_b32 v108, 0
    v_mov_b32 v109, 0
    v_mov_b32 v110, 0
    v_mov_b32 v111, 0
    v_mov_b32 v112, 0
    v_mov_b32 v113, 0
    v_mov_b32 v114, 0
    v_mov_b32 v115, 0
    v_mov_b32 v116, 0
    v_mov_b32 v117, 0
    v_mov_b32 v118, 0
    v_mov_b32 v119, 0
    v_mov_b32 v120, 0
    v_mov_b32 v121, 0
    v_mov_b32 v122, 0
    v_mov_b32 v123, 0
    v_mov_b32 v124, 0
    v_mov_b32 v125, 0
    v_mov_b32 v126, 0
    v_mov_b32 v127, 0
    s_lshl_b32 s3, s4, 1
    s_add_u32 s3, s3, s60
    s_lshl_b32 s59, s3, 12
    s_lshl_b32 s3, s61, 10
    s_add_u32 s59, s59, s3
    s_add_u32 s59, s59, 16842752
    s_waitcnt vmcnt(0)
    s_barrier
    s_mov_b32 exec_lo, 0xff
    s_mov_b32 exec_hi, 0
    s_mov_b32 s65, 0
F_pollo:
    buffer_load_dword v12, v10, s[52:55], s59 offen sc1
F_pchko:
    s_waitcnt vmcnt(0)
    v_cmp_ne_u32 vcc, s71, v12
    s_add_u32 s65, s65, 1
    s_nop 0
    s_cmp_eq_u64 vcc, 0
    s_cbranch_scc1 F_pdoneo
    s_cmp_gt_u32 s65, 0x200000
    s_cbranch_scc1 F_pdoneo
    s_mov_b64 exec, vcc
    s_sleep 2
    s_branch F_pollo
F_pdoneo:
    s_mov_b64 exec, -1
    s_add_u32 s63, s62, 0
    buffer_load_dwordx4 v[16:19], v2, s[52:55], s63 offen offset:0 sc1
    buffer_load_dwordx4 v[20:23], v2, s[52:55], s63 offen offset:1024 sc1
    s_add_u32 s63, s62, 131072
    buffer_load_dwordx4 v[24:27], v2, s[52:55], s63 offen offset:0 sc1
    buffer_load_dwordx4 v[28:31], v2, s[52:55], s63 offen offset:1024 sc1
    s_add_u32 s63, s62, 262144
    buffer_load_dwordx4 v[32:35], v2, s[52:55], s63 offen offset:0 sc1
    buffer_load_dwordx4 v[36:39], v2, s[52:55], s63 offen offset:1024 sc1
    s_add_u32 s63, s62, 393216
    buffer_load_dwordx4 v[40:43], v2, s[52:55], s63 offen offset:0 sc1
    buffer_load_dwordx4 v[44:47], v2, s[52:55], s63 offen offset:1024 sc1
    s_add_u32 s63, s62, 524288
    buffer_load_dwordx4 v[48:51], v2, s[52:55], s63 offen offset:0 sc1
    buffer_load_dwordx4 v[52:55], v2, s[52:55], s63 offen offset:1024 sc1
    s_add_u32 s63, s62, 655360
    buffer_load_dwordx4 v[56:59], v2, s[52:55], s63 offen offset:0 sc1
    buffer_load_dwordx4 v[60:63], v2, s[52:55], s63 offen offset:1024 sc1
    s_add_u32 s63, s62, 786432
    buffer_load_dwordx4 v[64:67], v2, s[52:55], s63 offen offset:0 sc1
    buffer_load_dwordx4 v[68:71], v2, s[52:55], s63 offen offset:1024 sc1
    s_add_u32 s63, s62, 917504
    buffer_load_dwordx4 v[72:75], v2, s[52:55], s63 offen offset:0 sc1
    buffer_load_dwordx4 v[76:79], v2, s[52:55], s63 offen offset:1024 sc1
    ds_read_b64_tr_b16 v[80:81], v14 offset:0
    ds_read_b64_tr_b16 v[82:83], v14 offset:1024
    ds_read_b64_tr_b16 v[84:85], v15 offset:0
    ds_read_b64_tr_b16 v[86:87], v15 offset:1024
    ds_read_b64_tr_b16 v[88:89], v14 offset:2048
    ds_read_b64_tr_b16 v[90:91], v14 offset:3072
    ds_read_b64_tr_b16 v[92:93], v15 offset:2048
    ds_read_b64_tr_b16 v[94:95], v15 offset:3072
    s_waitcnt vmcnt(15) lgkmcnt(4)
    v_mfma_f32_32x32x16_bf16 v[96:111], v[80:83], v[16:19], v[96:111]
    v_mfma_f32_32x32x16_bf16 v[112:127], v[84:87], v[16:19], v[112:127]
    ds_read_b64_tr_b16 v[80:81], v14 offset:3584
    ds_read_b64_tr_b16 v[82:83], v14 offset:4608
    ds_read_b64_tr_b16 v[84:85], v15 offset:3584
    ds_read_b64_tr_b16 v[86:87], v15 offset:4608
    s_waitcnt vmcnt(14) lgkmcnt(4)
    v_mfma_f32_32x32x16_bf16 v[96:111], v[88:91], v[20:23], v[96:111]
    v_mfma_f32_32x32x16_bf16 v[112:127], v[92:95], v[20:23], v[112:127]
    ds_read_b64_tr_b16 v[88:89], v14 offset:5632
    ds_read_b64_tr_b16 v[90:91], v14 offset:6656
    ds_read_b64_tr_b16 v[92:93], v15 offset:5632
    ds_read_b64_tr_b16 v[94:95], v15 offset:6656
    s_waitcnt vmcnt(13) lgkmcnt(4)
    v_mfma_f32_32x32x16_bf16 v[96:111], v[80:83], v[24:27], v[96:111]
    v_mfma_f32_32x32x16_bf16 v[112:127], v[84:87], v[24:27], v[112:127]
    ds_read_b64_tr_b16 v[80:81], v14 offset:7168
    ds_read_b64_tr_b16 v[82:83], v14 offset:8192
    ds_read_b64_tr_b16 v[84:85], v15 offset:7168
    ds_read_b64_tr_b16 v[86:87], v15 offset:8192
    s_waitcnt vmcnt(12) lgkmcnt(4)
    v_mfma_f32_32x32x16_bf16 v[96:111], v[88:91], v[28:31], v[96:111]
    v_mfma_f32_32x32x16_bf16 v[112:127], v[92:95], v[28:31], v[112:127]
    ds_read_b64_tr_b16 v[88:89], v14 offset:9216
    ds_read_b64_tr_b16 v[90:91], v14 offset:10240
    ds_read_b64_tr_b16 v[92:93], v15 offset:9216
    ds_read_b64_tr_b16 v[94:95], v15 offset:10240
    s_waitcnt vmcnt(11) lgkmcnt(4)
    v_mfma_f32_32x32x16_bf16 v[96:111], v[80:83], v[32:35], v[96:111]
    v_mfma_f32_32x32x16_bf16 v[112:127], v[84:87], v[32:35], v[112:127]
    ds_read_b64_tr_b16 v[80:81], v14 offset:10752
    ds_read_b64_tr_b16 v[82:83], v14 offset:11776
    ds_read_b64_tr_b16 v[84:85], v15 offset:10752
    ds_read_b64_tr_b16 v[86:87], v15 offset:11776
    s_waitcnt vmcnt(10) lgkmcnt(4)
    v_mfma_f32_32x32x16_bf16 v[96:111], v[88:91], v[36:39], v[96:111]
    v_mfma_f32_32x32x16_bf16 v[112:127], v[92:95], v[36:39], v[112:127]
    ds_read_b64_tr_b16 v[88:89], v14 offset:12800
    ds_read_b64_tr_b16 v[90:91], v14 offset:13824
    ds_read_b64_tr_b16 v[92:93], v15 offset:12800
    ds_read_b64_tr_b16 v[94:95], v15 offset:13824
    s_waitcnt vmcnt(9) lgkmcnt(4)
    v_mfma_f32_32x32x16_bf16 v[96:111], v[80:83], v[40:43], v[96:111]
    v_mfma_f32_32x32x16_bf16 v[112:127], v[84:87], v[40:43], v[112:127]
    ds_read_b64_tr_b16 v[80:81], v14 offset:14336
    ds_read_b64_tr_b16 v[82:83], v14 offset:15360
    ds_read_b64_tr_b16 v[84:85], v15 offset:14336
    ds_read_b64_tr_b16 v[86:87], v15 offset:15360
    s_waitcnt vmcnt(8) lgkmcnt(4)
    v_mfma_f32_32x32x16_bf16 v[96:111], v[88:91], v[44:47], v[96:111]
    v_mfma_f32_32x32x16_bf16 v[112:127], v[92:95], v[44:47], v[112:127]
    ds_read_b64_tr_b16 v[88:89], v14 offset:16384
    ds_read_b64_tr_b16 v[90:91], v14 offset:17408
    ds_read_b64_tr_b16 v[92:93], v15 offset:16384
    ds_read_b64_tr_b16 v[94:95], v15 offset:17408
    s_waitcnt vmcnt(7) lgkmcnt(4)
    v_mfma_f32_32x32x16_bf16 v[96:111], v[80:83], v[48:51], v[96:111]
    v_mfma_f32_32x32x16_bf16 v[112:127], v[84:87], v[48:51], v[112:127]
    ds_read_b64_tr_b16 v[80:81], v14 offset:17920
    ds_read_b64_tr_b16 v[82:83], v14 offset:18944
    ds_read_b64_tr_b16 v[84:85], v15 offset:17920
    ds_read_b64_tr_b16 v[86:87], v15 offset:18944
    s_waitcnt vmcnt(6) lgkmcnt(4)
    v_mfma_f32_32x32x16_bf16 v[96:111], v[88:91], v[52:55], v[96:111]
    v_mfma_f32_32x32x16_bf16 v[112:127], v[92:95], v[52:55], v[112:127]
    ds_read_b64_tr_b16 v[88:89], v14 offset:19968
    ds_read_b64_tr_b16 v[90:91], v14 offset:20992
    ds_read_b64_tr_b16 v[92:93], v15 offset:19968
    ds_read_b64_tr_b16 v[94:95], v15 offset:20992
    s_waitcnt vmcnt(5) lgkmcnt(4)
    v_mfma_f32_32x32x16_bf16 v[96:111], v[80:83], v[56:59], v[96:111]
    v_mfma_f32_32x32x16_bf16 v[112:127], v[84:87], v[56:59], v[112:127]
    ds_read_b64_tr_b16 v[80:81], v14 offset:21504
    ds_read_b64_tr_b16 v[82:83], v14 offset:22528
    ds_read_b64_tr_b16 v[84:85], v15 offset:21504
    ds_read_b64_tr_b16 v[86:87], v15 offset:22528
    s_waitcnt vmcnt(4) lgkmcnt(4)
    v_mfma_f32_32x32x16_bf16 v[96:111], v[88:91], v[60:63], v[96:111]
    v_mfma_f32_32x32x16_bf16 v[112:127], v[92:95], v[60:63], v[112:127]
    ds_read_b64_tr_b16 v[88:89], v14 offset:23552
    ds_read_b64_tr_b16 v[90:91], v14 offset:24576
    ds_read_b64_tr_b16 v[92:93], v15 offset:23552
    ds_read_b64_tr_b16 v[94:95], v15 offset:24576
    s_waitcnt vmcnt(3) lgkmcnt(4)
    v_mfma_f32_32x32x16_bf16 v[96:111], v[80:83], v[64:67], v[96:111]
    v_mfma_f32_32x32x16_bf16 v[112:127], v[84:87], v[64:67], v[112:127]
    ds_read_b64_tr_b16 v[80:81], v14 offset:25088
    ds_read_b64_tr_b16 v[82:83], v14 offset:26112
    ds_read_b64_tr_b16 v[84:85], v15 offset:25088
    ds_read_b64_tr_b16 v[86:87], v15 offset:26112
    s_waitcnt vmcnt(2) lgkmcnt(4)
    v_mfma_f32_32x32x16_bf16 v[96:111], v[88:91], v[68:71], v[96:111]
    v_mfma_f32_32x32x16_bf16 v[112:127], v[92:95], v[68:71], v[112:127]
    ds_read_b64_tr_b16 v[88:89], v14 offset:27136
    ds_read_b64_tr_b16 v[90:91], v14 offset:28160
    ds_read_b64_tr_b16 v[92:93], v15 offset:27136
    ds_read_b64_tr_b16 v[94:95], v15 offset:28160
    s_waitcnt vmcnt(1) lgkmcnt(4)
    v_mfma_f32_32x32x16_bf16 v[96:111], v[80:83], v[72:75], v[96:111]
    v_mfma_f32_32x32x16_bf16 v[112:127], v[84:87], v[72:75], v[112:127]
    s_waitcnt vmcnt(0) lgkmcnt(0)
    v_mfma_f32_32x32x16_bf16 v[96:111], v[88:91], v[76:79], v[96:111]
    v_mfma_f32_32x32x16_bf16 v[112:127], v[92:95], v[76:79], v[112:127]
    s_nop 15
    s_barrier
    s_lshl_b32 s62, s9, 13
    v_add_u32 v6, s62, v2
    ds_write_b128 v6, v[96:99] offset:0
    ds_write_b128 v6, v[100:103] offset:1024
    ds_write_b128 v6, v[104:107] offset:2048
    ds_write_b128 v6, v[108:111] offset:3072
    ds_write_b128 v6, v[112:115] offset:4096
    ds_write_b128 v6, v[116:119] offset:5120
    ds_write_b128 v6, v[120:123] offset:6144
    ds_write_b128 v6, v[124:127] offset:7168
    s_waitcnt lgkmcnt(0)
    s_barrier
    s_lshr_b32 s61, s9, 1
    s_and_b32 s61, s61, 1
    s_lshr_b32 s57, s9, 2
    s_lshl_b32 s62, s60, 13
    s_lshl_b32 s63, s61, 12
    s_add_u32 s62, s62, s63
    s_lshl_b32 s63, s57, 11
    s_add_u32 s62, s62, s63
    v_add_u32 v6, s62, v2
    ds_read_b128 v[16:19], v6 offset:0
    ds_read_b128 v[20:23], v6 offset:1024
    ds_read_b128 v[24:27], v6 offset:16384
    ds_read_b128 v[28:31], v6 offset:17408
    v_add_u32 v6, 32768, v6
    ds_read_b128 v[32:35], v6 offset:0
    ds_read_b128 v[36:39], v6 offset:1024
    ds_read_b128 v[40:43], v6 offset:16384
    ds_read_b128 v[44:47], v6 offset:17408
    s_waitcnt lgkmcnt(0)
    v_add_f32 v16, v16, v24
    v_add_f32 v32, v32, v40
    v_add_f32 v17, v17, v25
    v_add_f32 v33, v33, v41
    v_add_f32 v18, v18, v26
    v_add_f32 v34, v34, v42
    v_add_f32 v19, v19, v27
    v_add_f32 v35, v35, v43
    v_add_f32 v20, v20, v28
    v_add_f32 v36, v36, v44
    v_add_f32 v21, v21, v29
    v_add_f32 v37, v37, v45
    v_add_f32 v22, v22, v30
    v_add_f32 v38, v38, v46
    v_add_f32 v23, v23, v31
    v_add_f32 v39, v39, v47
    v_add_f32 v16, v16, v32
    v_add_f32 v17, v17, v33
    v_add_f32 v18, v18, v34
    v_add_f32 v19, v19, v35
    v_add_f32 v20, v20, v36
    v_add_f32 v21, v21, v37
    v_add_f32 v22, v22, v38
    v_add_f32 v23, v23, v39
    v_cvt_pk_bf16_f32 v48, v16, v17
    v_cvt_pk_bf16_f32 v49, v18, v19
    v_cvt_pk_bf16_f32 v50, v20, v21
    v_cvt_pk_bf16_f32 v51, v22, v23
    v_and_b32 v6, 31, v1
    v_lshrrev_b32 v7, 5, v1
    v_permlane32_swap_b32 v48, v50
    v_permlane32_swap_b32 v49, v51
    v_mul_u32_u24 v6, 896, v6
    v_lshl_add_u32 v6, v7, 4, v6
    s_lshl_b32 s62, s4, 1
    s_add_u32 s62, s62, s60
    s_mul_i32 s62, s62, 28672
    s_add_u32 s62, s62, s56
    s_lshl_b32 s63, s61, 6
    s_add_u32 s62, s62, s63
    s_lshl_b32 s63, s57, 5
    s_add_u32 s62, s62, s63
    buffer_store_dwordx4 v[48:51], v6, s[48:51], s62 offen
F_end:
F_done:
    s_endpgm
F_slow:
    s_mov_b64 exec, s[68:69]
    v_mov_b32 v22, 0
    s_mov_b64 exec, -1
    v_mov_b32 v8, 0xff800000
    s_mov_b32 s60, 0
    v_mov_b32 v88, 0
    v_mov_b32 v89, 0
    v_mov_b32 v90, 0
    v_mov_b32 v91, 0
    v_mov_b32 v92, 0
    v_mov_b32 v93, 0
    v_mov_b32 v94, 0
    v_mov_b32 v95, 0
    v_mov_b32 v96, 0
    v_mov_b32 v97, 0
    v_mov_b32 v98, 0
    v_mov_b32 v99, 0
    v_mov_b32 v100, 0
    v_mov_b32 v101, 0
    v_mov_b32 v102, 0
    v_mov_b32 v103, 0
F_sin:
    buffer_load_dwordx4 v[72:75], v2, s[36:39], s60 offen sc1
    buffer_load_dwordx4 v[76:79], v2, s[36:39], s60 offen offset:1024 sc1
    buffer_load_dwordx4 v[80:83], v2, s[36:39], s60 offen offset:2048 sc1
    buffer_load_dwordx4 v[84:87], v2, s[36:39], s60 offen offset:3072 sc1
    s_waitcnt vmcnt(0)
    v_mfma_f32_32x32x16_bf16 v[32:47], v[72:75], v[16:19], 0
    v_mfma_f32_32x32x16_bf16 v[32:47], v[76:79], v[20:23], v[32:47]
    s_nop 15
    v_max3_f32 v5, v32, v33, v34
    v_max3_f32 v5, v5, v35, v36
    v_max3_f32 v5, v5, v37, v38
    v_max3_f32 v5, v5, v39, v40
    v_max3_f32 v5, v5, v41, v42
    v_max3_f32 v5, v5, v43, v44
    v_max3_f32 v5, v5, v45, v46
    v_max_f32 v5, v5, v47
    s_nop 0
    v_mov_b32 v6, v5
    s_nop 1
    v_permlane32_swap_b32 v5, v6
    s_nop 1
    v_max3_f32 v5, v5, v6, v8
    v_sub_f32 v6, v8, v5
    v_exp_f32 v6, v6
    v_mov_b32 v8, v5
    v_sub_f32 v32, v32, v5
    v_sub_f32 v33, v33, v5
    v_sub_f32 v34, v34, v5
    v_sub_f32 v35, v35, v5
    v_sub_f32 v36, v36, v5
    v_sub_f32 v37, v37, v5
    v_sub_f32 v38, v38, v5
    v_sub_f32 v39, v39, v5
    v_sub_f32 v40, v40, v5
    v_sub_f32 v41, v41, v5
    v_sub_f32 v42, v42, v5
    v_sub_f32 v43, v43, v5
    v_sub_f32 v44, v44, v5
    v_sub_f32 v45, v45, v5
    v_sub_f32 v46, v46, v5
    v_sub_f32 v47, v47, v5
    v_exp_f32 v32, v32
    v_exp_f32 v33, v33
    v_exp_f32 v34, v34
    v_exp_f32 v35, v35
    v_exp_f32 v36, v36
    v_exp_f32 v37, v37
    v_exp_f32 v38, v38
    v_exp_f32 v39, v39
    v_exp_f32 v40, v40
    v_exp_f32 v41, v41
    v_exp_f32 v42, v42
    v_exp_f32 v43, v43
    v_exp_f32 v44, v44
    v_exp_f32 v45, v45
    v_exp_f32 v46, v46
    v_exp_f32 v47, v47
    v_mul_f32 v88, v88, v6
    v_mul_f32 v89, v89, v6
    v_mul_f32 v90, v90, v6
    v_mul_f32 v91, v91, v6
    v_mul_f32 v92, v92, v6
    v_mul_f32 v93, v93, v6
    v_mul_f32 v94, v94, v6
    v_mul_f32 v95, v95, v6
    v_mul_f32 v96, v96, v6
    v_mul_f32 v97, v97, v6
    v_mul_f32 v98, v98, v6
    v_mul_f32 v99, v99, v6
    v_mul_f32 v100, v100, v6
    v_mul_f32 v101, v101, v6
    v_mul_f32 v102, v102, v6
    v_mul_f32 v103, v103, v6
    v_cvt_pk_bf16_f32 v64, v32, v33
    v_cvt_pk_bf16_f32 v65, v34, v35
    v_cvt_pk_bf16_f32 v66, v36, v37
    v_cvt_pk_bf16_f32 v67, v38, v39
    v_cvt_pk_bf16_f32 v68, v40, v41
    v_cvt_pk_bf16_f32 v69, v42, v43
    v_cvt_pk_bf16_f32 v70, v44, v45
    v_cvt_pk_bf16_f32 v71, v46, v47
    s_nop 1
    v_mfma_f32_32x32x16_bf16 v[88:103], v[80:83], v[64:67], v[88:103]
    v_mfma_f32_32x32x16_bf16 v[88:103], v[84:87], v[68:71], v[88:103]
    s_nop 15
    s_add_u32 s60, s60, 4096
    s_cmp_lt_u32 s60, 0x40000
    s_cbranch_scc1 F_sin
    s_mov_b32 s70, 1
    s_branch F_final
.section .rodata,"a"
.p2align 6
.amdhsa_kernel gated_mix__mha_block__softmax_full_mha__prompt_kernel
  .amdhsa_next_free_vgpr 144
  .amdhsa_next_free_sgpr 72
  .amdhsa_accum_offset 144
  .amdhsa_group_segment_fixed_size 0
  .amdhsa_kernarg_size 80
  .amdhsa_user_sgpr_count 2
  .amdhsa_user_sgpr_kernarg_segment_ptr 1
  .amdhsa_system_sgpr_workgroup_id_x 1
.end_amdhsa_kernel
```
